```python
import torch

def _softmax(x, axis=-1):
    return torch.softmax(x, dim=axis)
def _gelu(x):
    return torch.nn.functional.gelu(x, approximate="tanh")
def _silu(x):
    return torch.nn.functional.silu(x)
def _sigmoid(x):
    return torch.sigmoid(x)
def _layernorm(x, axis=-1, eps=1e-5):
    m = x.mean(dim=axis, keepdim=True)
    v = x.var(dim=axis, keepdim=True, unbiased=False)
    return (x - m) / torch.sqrt(v + eps)
def _scatter_add(tgt, idx, src, axis=0):
    return tgt.clone().index_add_(axis, idx, src)
def _segment_sum(src, seg, n):
    out = torch.zeros((n,) + src.shape[1:], dtype=src.dtype)
    return out.index_add_(0, seg, src)
def _pad(x, pw):
    flat = tuple(v for pair in reversed(pw) for v in pair)
    return torch.nn.functional.pad(x, flat)

kernel_name = 'parallel_sum__compressed_kv_cla__glu_gated_geglu__decode'

def setup_inputs():

    _w = (lambda a: (lambda t: t.to(torch.bfloat16) if t.is_floating_point() else t)(torch.as_tensor(a)))
    def _A_setup():
        B, H, Sq, Sk, D, M = 4, 32, 1, 4096, 128, 512
        Dc = 4 * D
        return {
            "x": _w((lambda *s: torch.randn(*s, dtype=torch.bfloat16) * 0.05)(B, Sq, M)),
            "c_kv": _w((lambda *s: torch.randn(*s, dtype=torch.bfloat16) * 0.8)(B, Sk, Dc)),
            "w_q": _w((lambda *s: torch.randn(*s, dtype=torch.bfloat16) * 1.6)(M, H, D) * (M ** -0.5)),
            "w_uk": _w((lambda *s: torch.randn(*s, dtype=torch.bfloat16) * 1.6)(Dc, H, D) * (Dc ** -0.5)),
            "w_uv": _w((lambda *s: torch.randn(*s, dtype=torch.bfloat16) * 0.8)(Dc, H, D) * (Dc ** -0.5)),
            "w_o": _w((lambda *s: torch.randn(*s, dtype=torch.bfloat16) * 0.8)(H, D, M) * ((H * D) ** -0.5)),
        }
    _A_in = _A_setup()

    def _B_setup():
        B, S, Dm, Df = 4, 1, 512, 1792
        return {
            "x": _w((lambda *s: torch.randn(*s, dtype=torch.bfloat16) * 0.05)(B, S, Dm)),
            "w_gate": _w((lambda *s: torch.randn(*s, dtype=torch.bfloat16) * 0.4)(Dm, Df) * (Dm ** -0.5)),
            "w_up": _w((lambda *s: torch.randn(*s, dtype=torch.bfloat16) * 0.4)(Dm, Df) * (Dm ** -0.5)),
            "w_down": _w((lambda *s: torch.randn(*s, dtype=torch.bfloat16) * 0.4)(Df, Dm) * (Df ** -0.5)),
        }
    _B_in = _B_setup()

    return {
        "A_x": _A_in["x"],
        "A_c_kv": _A_in["c_kv"],
        "A_w_q": _A_in["w_q"],
        "A_w_uk": _A_in["w_uk"],
        "A_w_uv": _A_in["w_uv"],
        "A_w_o": _A_in["w_o"],
        "B_x": _B_in["x"],
        "B_w_gate": _B_in["w_gate"],
        "B_w_up": _B_in["w_up"],
        "B_w_down": _B_in["w_down"],
    }

def reference(A_x, A_c_kv, A_w_q, A_w_uk, A_w_uv, A_w_o, B_x, B_w_gate, B_w_up, B_w_down):
    def _A_ref(x, c_kv, w_q, w_uk, w_uv, w_o):
        B, Sq, M = x.shape[0], x.shape[1], x.shape[2]
        Sk = c_kv.shape[1]
        H, D = w_q.shape[1], w_q.shape[2]
        q = torch.einsum("bqm,mhd->bhqd", x, w_q)
        k = torch.einsum("bkc,chd->bhkd", c_kv, w_uk)
        v = torch.einsum("bkc,chd->bhkd", c_kv, w_uv)
        scores = torch.einsum("bhqd,bhkd->bhqk", q, k) * (D ** -0.5)
        off = Sk - Sq
        qi = torch.arange(Sq)[:, None]
        kj = torch.arange(Sk)[None, :]
        cmask = kj <= (qi + off)
        scores = torch.where(cmask[None, None], scores, -1e9)
        p = _softmax(scores, axis=-1)
        ctx = torch.einsum("bhqk,bhkd->bhqd", p, v)
        return torch.einsum("bhqd,hdm->bqm", ctx, w_o)

    def _B_ref(x, w_gate, w_up, w_down):
        g = torch.einsum("bsd,df->bsf", x, w_gate)
        u = torch.einsum("bsd,df->bsf", x, w_up)
        h = _gelu(g) * u
        return torch.einsum("bsf,fd->bsd", h, w_down)

    x = A_x
    xn = _layernorm(x, axis=-1)
    return x + _A_ref(xn, A_c_kv, A_w_q, A_w_uk, A_w_uv, A_w_o) + _B_ref(xn, B_w_gate, B_w_up, B_w_down)
```

```asm
; @launch grid=(256,1,1) block=(256,1,1) lds=163840
.amdgcn_target "amdgcn-amd-amdhsa--gfx950"
.text
.globl parallel_sum__compressed_kv_cla__glu_gated_geglu__decode_kernel
.p2align 8
.type parallel_sum__compressed_kv_cla__glu_gated_geglu__decode_kernel,@function
parallel_sum__compressed_kv_cla__glu_gated_geglu__decode_kernel:
    s_load_dwordx16 s[4:19], s[0:1], 0
    s_load_dwordx8 s[20:27], s[0:1], 64
    s_load_dwordx2 s[28:29], s[0:1], 96
    s_cmp_ge_u32 s2, 256
    s_cbranch_scc1 L_end
    v_lshrrev_b32 v2, 6, v0
    v_and_b32 v1, 63, v0
    v_readfirstlane_b32 s30, v2
    s_and_b32 s31, s2, 7
    s_lshr_b32 s32, s2, 4
    s_getpc_b64 s[58:59]
L_pc:
    s_lshr_b32 s34, s2, 3
    s_lshl_b32 s34, s34, 10
    v_lshrrev_b32 v3, 5, v0
    v_lshl_add_u32 v3, v3, 7, s34
    v_min_u32 v3, L_end-L_pc, v3
    global_load_dword v2, v3, s[58:59]
    v_lshrrev_b32 v4, 4, v1
    v_and_b32 v5, 15, v1
    v_xor_b32 v6, v4, v5
    s_mov_b32 s38, 4194304
    s_mov_b32 s39, 0x20000
    s_bitcmp1_b32 s2, 3
    s_cbranch_scc1 L_X
    s_lshr_b32 s63, s32, 2
    s_lshl_b32 s34, s31, 2
    s_add_u32 s63, s63, s34
    s_and_b32 s3, s32, 3
    s_lshl_b32 s35, s63, 8
    s_lshl_b32 s34, s30, 16
    s_add_u32 s34, s34, s35
    v_lshl_add_u32 v14, v4, 18, s34
    v_lshl_add_u32 v14, v5, 4, v14
    v_xor_b32 v8, s30, v5
    v_and_b32 v8, 3, v8
    v_lshlrev_b32 v8, 4, v8
    v_lshrrev_b32 v9, 2, v5
    v_lshl_add_u32 v8, v9, 10, v8
    v_lshl_add_u32 v8, v4, 6, v8
    v_lshl_add_u32 v8, s3, 8, v8
    s_lshl_b32 s56, s3, 20
    s_and_b32 s33, s30, 1
    s_lshl_b32 s57, s3, 7
    s_add_u32 s57, s57, s63
    s_lshl_b32 s57, s57, 1
    s_add_u32 s57, s57, s33
    s_lshl_b32 s57, s57, 8
    s_add_u32 s57, s57, s30
    s_lshl_b32 s57, s57, 5
    s_add_u32 s57, s57, 1580800
    s_lshr_b32 s34, s31, 2
    s_xor_b32 s33, s33, s34
    v_mov_b32 v238, 40960
    v_mov_b32 v12, 2
    v_mov_b32 v13, s33
    ds_write_b32 v238, v12
    s_waitcnt lgkmcnt(0)
    s_load_dword s33, s[28:29], s57 glc
    s_mov_b32 s36, s8
    s_and_b32 s37, s9, 0xffff
    buffer_load_dwordx4 v[64:67], v14, s[36:39], s56 offen
    s_addk_i32 s56, 0x2000
    buffer_load_dwordx4 v[68:71], v14, s[36:39], s56 offen
    s_addk_i32 s56, 0x2000
    buffer_load_dwordx4 v[72:75], v14, s[36:39], s56 offen
    s_addk_i32 s56, 0x2000
    buffer_load_dwordx4 v[76:79], v14, s[36:39], s56 offen
    global_load_dwordx4 v[16:19], v8, s[4:5]
    v_xor_b32 v9, 256, v8
    global_load_dwordx4 v[20:23], v9, s[4:5]
    v_xor_b32 v9, 512, v8
    global_load_dwordx4 v[24:27], v9, s[4:5]
    v_xor_b32 v9, 768, v8
    global_load_dwordx4 v[28:31], v9, s[4:5]
    s_addk_i32 s56, 0x2000
    buffer_load_dwordx4 v[80:83], v14, s[36:39], s56 offen
    s_addk_i32 s56, 0x2000
    buffer_load_dwordx4 v[84:87], v14, s[36:39], s56 offen
    s_waitcnt lgkmcnt(0)
    ds_cmpst_b32 v238, v12, v13
    s_addk_i32 s56, 0x2000
    buffer_load_dwordx4 v[88:91], v14, s[36:39], s56 offen
    s_addk_i32 s56, 0x2000
    buffer_load_dwordx4 v[92:95], v14, s[36:39], s56 offen
    s_xor_b32 s56, s3, 1
    s_lshl_b32 s56, s56, 20
    buffer_load_dwordx4 v[96:99], v14, s[36:39], s56 offen
    s_addk_i32 s56, 0x2000
    buffer_load_dwordx4 v[100:103], v14, s[36:39], s56 offen
    s_addk_i32 s56, 0x2000
    buffer_load_dwordx4 v[104:107], v14, s[36:39], s56 offen
    s_addk_i32 s56, 0x2000
    buffer_load_dwordx4 v[108:111], v14, s[36:39], s56 offen
    s_addk_i32 s56, 0x2000
    buffer_load_dwordx4 v[112:115], v14, s[36:39], s56 offen
    s_addk_i32 s56, 0x2000
    buffer_load_dwordx4 v[116:119], v14, s[36:39], s56 offen
    s_addk_i32 s56, 0x2000
    buffer_load_dwordx4 v[120:123], v14, s[36:39], s56 offen
    s_addk_i32 s56, 0x2000
    buffer_load_dwordx4 v[124:127], v14, s[36:39], s56 offen
    s_branch L_Y
L_X:
    s_lshl_b32 s63, s31, 4
    s_add_u32 s63, s63, s32
    s_mul_i32 s3, s30, 26112
    s_lshl_b32 s34, s63, 17
    s_lshl_b32 s35, s30, 15
    s_add_u32 s34, s34, s35
    v_lshl_add_u32 v6, v6, 4, s34
    v_lshl_add_u32 v30, v4, 10, v6
    s_lshl_b32 s34, s31, 10
    v_lshl_add_u32 v7, v1, 4, s34
    s_lshl_b32 s34, s30, 13
    s_add_u32 m0, s34, 104448
    s_lshl_b32 s56, s32, 2
    s_add_u32 s56, s56, s30
    s_lshl_b32 s56, s56, 16
    s_add_u32 s34, s56, 16384
    s_waitcnt lgkmcnt(0)
    s_mov_b32 s36, s8
    s_and_b32 s37, s9, 0xffff
    buffer_load_dwordx4 v7, s[36:39], s34 offen lds
    s_addk_i32 s34, 0x2000
    buffer_load_dwordx4 v7, s[36:39], s34 offen lds
    s_addk_i32 s34, 0x2000
    buffer_load_dwordx4 v7, s[36:39], s34 offen lds
    s_addk_i32 s34, 0x2000
    buffer_load_dwordx4 v7, s[36:39], s34 offen lds
    s_addk_i32 s34, 0x2000
    buffer_load_dwordx4 v7, s[36:39], s34 offen lds
    s_addk_i32 s34, 0x2000
    buffer_load_dwordx4 v7, s[36:39], s34 offen lds
    s_addk_i32 s34, 0x2000
    s_mov_b32 s36, s10
    s_and_b32 s37, s11, 0xffff
    buffer_load_dwordx4 v7, s[36:39], s56 offen lds
    s_addk_i32 s56, 0x2000
    buffer_load_dwordx4 v7, s[36:39], s56 offen lds
    s_addk_i32 s56, 0x2000
    buffer_load_dwordx4 v7, s[36:39], s56 offen lds
    s_addk_i32 s56, 0x2000
    buffer_load_dwordx4 v7, s[36:39], s56 offen lds
    s_addk_i32 s56, 0x2000
    buffer_load_dwordx4 v7, s[36:39], s56 offen lds
    s_addk_i32 s56, 0x2000
    buffer_load_dwordx4 v7, s[36:39], s56 offen lds
    s_addk_i32 s56, 0x2000
    buffer_load_dwordx4 v7, s[36:39], s56 offen lds
    s_addk_i32 s56, 0x2000
    buffer_load_dwordx4 v7, s[36:39], s56 offen lds
    s_addk_i32 s56, 0x2000
    s_mov_b32 s44, s6
    s_and_b32 s45, s7, 0xffff
    s_mov_b32 s46, 0x1000000
    s_mov_b32 s47, 0x20000
    s_load_dword s100, s[28:29], 0
    s_mov_b32 s60, 0
    s_mov_b32 s61, 0x05040100
    s_mov_b32 s62, 0x07060302
    s_mov_b32 s48, s28
    s_and_b32 s49, s29, 0xffff
    s_mov_b32 s50, 0x840000
    s_mov_b32 s51, 0x20000
    s_mov_b32 s52, s14
    s_and_b32 s53, s15, 0xffff
    s_mov_b32 s54, 0x400000
    s_mov_b32 s55, 0x20000
    v_bfe_u32 v6, v1, 2, 3
    v_mul_u32_u24 v6, 1088, v6
    v_and_b32 v7, 3, v1
    v_lshl_add_u32 v6, v7, 8, v6
    v_lshrrev_b32 v8, 5, v1
    v_lshlrev_b32 v9, 1, v8
    v_xor_b32 v9, v9, v7
    v_lshl_add_u32 v6, v9, 4, v6
    v_add_u32 v28, s3, v6
    v_xor_b32 v29, 16, v28
    v_and_b32 v10, 31, v1
    v_mul_u32_u24 v6, 384, v10
    v_add_u32 v6, 104448, v6
    v_bfe_u32 v7, v1, 1, 3
    v_lshl_add_u32 v9, v8, 7, v6
    v_lshl_add_u32 v16, v7, 4, v9
    v_lshlrev_b32 v9, 2, v8
    v_xor_b32 v9, v9, v7
    v_lshl_add_u32 v9, v9, 4, v6
    v_add_u32 v24, 256, v9
    v_xor_b32 v17, 16, v16
    v_xor_b32 v18, 32, v16
    v_xor_b32 v19, 48, v16
    v_xor_b32 v20, 64, v16
    v_xor_b32 v21, 80, v16
    v_xor_b32 v22, 96, v16
    v_xor_b32 v23, 112, v16
    v_xor_b32 v25, 16, v24
    v_xor_b32 v26, 32, v24
    v_xor_b32 v27, 48, v24
    s_lshr_b32 s16, s63, 1
    s_and_b32 s17, s32, 1
    s_lshl_b32 s40, s17, 15
    s_add_u32 s41, s40, 0x1000
    s_xor_b32 s42, s40, 0x8000
    s_add_u32 s43, s42, 0x1000
    s_lshl_b32 s34, s16, 16
    s_lshl_b32 s35, s30, 8
    s_add_u32 s34, s34, s35
    v_lshl_add_u32 v14, v4, 13, s34
    v_lshl_add_u32 v14, v5, 4, v14
    s_lshl_b32 s34, s17, 2
    s_add_u32 s34, s34, s30
    s_lshl_b32 s34, s34, 19
    s_lshl_b32 s35, s16, 7
    s_add_u32 s34, s34, s35
    v_lshrrev_b32 v6, 3, v1
    v_lshl_add_u32 v6, v6, 13, s34
    v_and_b32 v7, 7, v1
    v_bfe_u32 v9, v1, 4, 1
    v_lshlrev_b32 v9, 2, v9
    v_xor_b32 v7, v7, v9
    v_lshl_add_u32 v241, v7, 4, v6
    s_lshr_b32 s34, s31, 1
    s_mul_i32 s34, s34, 49152
    s_mul_i32 s27, s30, 3072
    s_add_u32 s34, s34, s27
    s_add_u32 s34, s34, 4096
    v_lshl_add_u32 v15, v1, 4, s34
    s_and_b32 s34, s63, 63
    s_lshl_b32 s34, s34, 3
    s_and_b32 s35, s30, 2
    s_mul_i32 s35, s35, 1
    s_add_u32 s35, s35, s30
    s_add_u32 s34, s34, s35
    s_lshr_b32 s35, s31, 2
    s_lshl_b32 s35, s35, 1
    s_add_u32 s34, s34, s35
    s_lshl_b32 s34, s34, 12
    s_xor_b32 s34, s34, 2097152
    v_lshl_add_u32 v13, v1, 4, s34
    v_lshlrev_b32 v6, 4, v10
    v_add_u32 v6, 153600, v6
    v_lshl_add_u32 v7, s30, 2, v6
    s_lshr_b32 s33, s63, 2
    s_and_b32 s34, s33, 15
    s_and_b32 s35, s33, 8
    s_add_u32 s34, s34, s35
    s_lshr_b32 s35, s33, 4
    s_lshl_b32 s35, s35, 3
    s_add_u32 s34, s34, s35
    s_lshl_b32 s34, s34, 4
    s_add_u32 s34, s34, s30
    s_lshl_b32 s34, s34, 4
    s_and_b32 s35, s63, 3
    s_add_u32 s34, s34, s35
    s_lshl_b32 s34, s34, 2
    s_add_u32 s34, s34, 393216
    v_lshl_add_u32 v249, v1, 8, s34
    s_and_b32 s57, s16, 31
    s_lshl_b32 s57, s57, 2
    s_add_u32 s57, s57, s30
    s_lshl_b32 s57, s57, 8
    s_add_u32 s57, s57, 0x40000
    s_add_u32 s58, s28, s57
    s_addc_u32 s59, s29, 0
    s_and_b32 s34, s16, 31
    s_lshl_b32 s34, s34, 10
    s_add_u32 s34, s34, 262144
    v_lshrrev_b32 v244, 2, v1
    v_lshl_add_u32 v244, v244, 6, s34
    v_and_b32 v245, 3, v1
    v_lshl_add_u32 v244, v245, 3, v244
    s_add_u32 s36, s32, 0
    s_and_b32 s36, s36, 3
    s_mul_i32 s36, s36, 12288
    s_add_u32 s37, s32, 1
    s_and_b32 s37, s37, 3
    s_mul_i32 s37, s37, 12288
    s_add_u32 s38, s32, 2
    s_and_b32 s38, s38, 3
    s_mul_i32 s38, s38, 12288
    s_add_u32 s39, s32, 3
    s_and_b32 s39, s39, 3
    s_mul_i32 s39, s39, 12288
    s_add_u32 m0, s3, 0
    s_add_u32 s56, s32, 0
    s_and_b32 s56, s56, 3
    s_lshl_b32 s56, s56, 8
    buffer_load_dwordx4 v30, s[44:47], s56 offen lds
    s_addk_i32 m0, 0x440
    s_addk_i32 s56, 0x1000
    buffer_load_dwordx4 v30, s[44:47], s56 offen lds
    s_addk_i32 m0, 0x440
    s_addk_i32 s56, 0x1000
    buffer_load_dwordx4 v30, s[44:47], s56 offen lds
    s_addk_i32 m0, 0x440
    s_addk_i32 s56, 0x1000
    buffer_load_dwordx4 v30, s[44:47], s56 offen lds
    s_addk_i32 m0, 0x440
    s_addk_i32 s56, 0x1000
    buffer_load_dwordx4 v30, s[44:47], s56 offen lds
    s_addk_i32 m0, 0x440
    s_addk_i32 s56, 0x1000
    buffer_load_dwordx4 v30, s[44:47], s56 offen lds
    s_addk_i32 m0, 0x440
    s_addk_i32 s56, 0x1000
    buffer_load_dwordx4 v30, s[44:47], s56 offen lds
    s_addk_i32 m0, 0x440
    s_addk_i32 s56, 0x1000
    buffer_load_dwordx4 v30, s[44:47], s56 offen lds
    s_add_u32 m0, s3, 8704
    s_add_u32 s56, s32, 1
    s_and_b32 s56, s56, 3
    s_lshl_b32 s56, s56, 8
    buffer_load_dwordx4 v30, s[44:47], s56 offen lds
    s_addk_i32 m0, 0x440
    s_addk_i32 s56, 0x1000
    buffer_load_dwordx4 v30, s[44:47], s56 offen lds
    s_addk_i32 m0, 0x440
    s_addk_i32 s56, 0x1000
    buffer_load_dwordx4 v30, s[44:47], s56 offen lds
    s_addk_i32 m0, 0x440
    s_addk_i32 s56, 0x1000
    buffer_load_dwordx4 v30, s[44:47], s56 offen lds
    s_addk_i32 m0, 0x440
    s_addk_i32 s56, 0x1000
    buffer_load_dwordx4 v30, s[44:47], s56 offen lds
    s_addk_i32 m0, 0x440
    s_addk_i32 s56, 0x1000
    buffer_load_dwordx4 v30, s[44:47], s56 offen lds
    s_addk_i32 m0, 0x440
    s_addk_i32 s56, 0x1000
    buffer_load_dwordx4 v30, s[44:47], s56 offen lds
    s_addk_i32 m0, 0x440
    s_addk_i32 s56, 0x1000
    buffer_load_dwordx4 v30, s[44:47], s56 offen lds
    s_add_u32 m0, s3, 17408
    s_add_u32 s56, s32, 2
    s_and_b32 s56, s56, 3
    s_lshl_b32 s56, s56, 8
    buffer_load_dwordx4 v30, s[44:47], s56 offen lds
    s_addk_i32 m0, 0x440
    s_addk_i32 s56, 0x1000
    buffer_load_dwordx4 v30, s[44:47], s56 offen lds
    s_addk_i32 m0, 0x440
    s_addk_i32 s56, 0x1000
    buffer_load_dwordx4 v30, s[44:47], s56 offen lds
    s_addk_i32 m0, 0x440
    s_addk_i32 s56, 0x1000
    buffer_load_dwordx4 v30, s[44:47], s56 offen lds
    s_addk_i32 m0, 0x440
    s_addk_i32 s56, 0x1000
    buffer_load_dwordx4 v30, s[44:47], s56 offen lds
    s_addk_i32 m0, 0x440
    s_addk_i32 s56, 0x1000
    buffer_load_dwordx4 v30, s[44:47], s56 offen lds
    s_addk_i32 m0, 0x440
    s_addk_i32 s56, 0x1000
    buffer_load_dwordx4 v30, s[44:47], s56 offen lds
    s_addk_i32 m0, 0x440
    s_addk_i32 s56, 0x1000
    buffer_load_dwordx4 v30, s[44:47], s56 offen lds
    s_waitcnt vmcnt(16)
    ds_read_b128 a[0:3], v28 offset:0
    ds_read_b128 a[4:7], v29 offset:0
    ds_read_b128 a[8:11], v28 offset:64
    ds_read_b128 a[12:15], v29 offset:64
    ds_read_b128 a[16:19], v28 offset:128
    ds_read_b128 a[20:23], v29 offset:128
    ds_read_b128 a[24:27], v28 offset:192
    ds_read_b128 a[28:31], v29 offset:192
    s_waitcnt lgkmcnt(0)
    s_mul_i32 s100, s100, 0x9e3779b1
    s_add_u32 s100, s100, 0x7f4a7c15
    s_mov_b32 s101, s100
    s_mul_i32 s99, s100, 3
    v_mov_b32 v248, s100
    s_getpc_b64 s[34:35]
L_pc2:
    s_lshl_b32 s57, s32, 2
    s_add_u32 s57, s57, s30
    s_lshl_b32 s57, s57, 7
    s_load_dword vcc_lo, s[34:35], s57
    s_add_u32 s57, s57, 0x2000
    s_min_u32 s57, s57, L_end-L_pc2
    s_load_dword vcc_lo, s[34:35], s57
    s_add_u32 s57, s57, 0x2000
    s_min_u32 s57, s57, L_end-L_pc2
    s_load_dword vcc_lo, s[34:35], s57
    s_add_u32 m0, s3, 0
    s_add_u32 s56, s32, 3
    s_and_b32 s56, s56, 3
    s_lshl_b32 s56, s56, 8
    buffer_load_dwordx4 v30, s[44:47], s56 offen lds
    s_addk_i32 m0, 0x440
    s_addk_i32 s56, 0x1000
    buffer_load_dwordx4 v30, s[44:47], s56 offen lds
    s_addk_i32 m0, 0x440
    s_addk_i32 s56, 0x1000
    buffer_load_dwordx4 v30, s[44:47], s56 offen lds
    s_addk_i32 m0, 0x440
    s_addk_i32 s56, 0x1000
    buffer_load_dwordx4 v30, s[44:47], s56 offen lds
    s_addk_i32 m0, 0x440
    s_addk_i32 s56, 0x1000
    buffer_load_dwordx4 v30, s[44:47], s56 offen lds
    s_addk_i32 m0, 0x440
    s_addk_i32 s56, 0x1000
    buffer_load_dwordx4 v30, s[44:47], s56 offen lds
    s_load_dwordx8 s[64:71], s[58:59], 0x0 glc
    s_load_dwordx8 s[72:79], s[58:59], 0x40 glc
    s_load_dwordx8 s[80:87], s[58:59], 0x80 glc
    s_load_dwordx8 s[88:95], s[58:59], 0xc0 glc
    s_addk_i32 m0, 0x440
    s_addk_i32 s56, 0x1000
    buffer_load_dwordx4 v30, s[44:47], s56 offen lds
    s_addk_i32 m0, 0x440
    s_addk_i32 s56, 0x1000
    buffer_load_dwordx4 v30, s[44:47], s56 offen lds
    s_waitcnt vmcnt(16)
    ds_read_b128 a[32:35], v28 offset:8704
    ds_read_b128 a[36:39], v29 offset:8704
    ds_read_b128 a[40:43], v28 offset:8768
    ds_read_b128 a[44:47], v29 offset:8768
    ds_read_b128 a[48:51], v28 offset:8832
    ds_read_b128 a[52:55], v29 offset:8832
    ds_read_b128 a[56:59], v28 offset:8896
    ds_read_b128 a[60:63], v29 offset:8896
    s_branch L_pollQw
L_pollQ:
    s_load_dwordx8 s[64:71], s[58:59], 0x0 glc
    s_load_dwordx8 s[72:79], s[58:59], 0x40 glc
    s_load_dwordx8 s[80:87], s[58:59], 0x80 glc
    s_load_dwordx8 s[88:95], s[58:59], 0xc0 glc
    s_add_u32 s60, s60, 1
    s_cmp_gt_u32 s60, 262144
    s_cbranch_scc1 L_exit
L_pollQw:
    s_waitcnt lgkmcnt(0)
    s_xor_b64 s[64:65], s[64:65], s[100:101]
    s_xor_b64 s[66:67], s[66:67], s[100:101]
    s_xor_b64 s[68:69], s[68:69], s[100:101]
    s_xor_b64 s[70:71], s[70:71], s[100:101]
    s_xor_b64 s[72:73], s[72:73], s[100:101]
    s_xor_b64 s[74:75], s[74:75], s[100:101]
    s_xor_b64 s[76:77], s[76:77], s[100:101]
    s_xor_b64 s[78:79], s[78:79], s[100:101]
    s_xor_b64 s[80:81], s[80:81], s[100:101]
    s_xor_b64 s[82:83], s[82:83], s[100:101]
    s_xor_b64 s[84:85], s[84:85], s[100:101]
    s_xor_b64 s[86:87], s[86:87], s[100:101]
    s_xor_b64 s[88:89], s[88:89], s[100:101]
    s_xor_b64 s[90:91], s[90:91], s[100:101]
    s_xor_b64 s[92:93], s[92:93], s[100:101]
    s_xor_b64 s[94:95], s[94:95], s[100:101]
    s_or_b64 s[64:65], s[64:65], s[80:81]
    s_or_b64 s[66:67], s[66:67], s[82:83]
    s_or_b64 s[68:69], s[68:69], s[84:85]
    s_or_b64 s[70:71], s[70:71], s[86:87]
    s_or_b64 s[72:73], s[72:73], s[88:89]
    s_or_b64 s[74:75], s[74:75], s[90:91]
    s_or_b64 s[76:77], s[76:77], s[92:93]
    s_or_b64 s[78:79], s[78:79], s[94:95]
    s_or_b64 s[64:65], s[64:65], s[72:73]
    s_or_b64 s[66:67], s[66:67], s[74:75]
    s_or_b64 s[68:69], s[68:69], s[76:77]
    s_or_b64 s[70:71], s[70:71], s[78:79]
    s_or_b64 s[64:65], s[64:65], s[68:69]
    s_or_b64 s[66:67], s[66:67], s[70:71]
    s_or_b64 s[64:65], s[64:65], s[66:67]
    s_or_b32 s64, s64, s65
    s_andn2_b32 s64, s64, 1
    s_cbranch_scc1 L_pollQ
    s_barrier
    buffer_load_dwordx2 v[246:247], v244, s[48:51], 0 offen sc1
    s_add_u32 m0, s27, 104448
    s_nop 0
    buffer_load_dwordx4 v15, s[48:51], s36 offen offset:0 sc1 lds
    buffer_load_dwordx4 v15, s[48:51], s36 offen offset:1024 sc1 lds
    buffer_load_dwordx4 v15, s[48:51], s36 offen offset:2048 sc1 lds
    s_add_u32 m0, s27, 116736
    s_nop 0
    buffer_load_dwordx4 v15, s[48:51], s37 offen offset:0 sc1 lds
    buffer_load_dwordx4 v15, s[48:51], s37 offen offset:1024 sc1 lds
    buffer_load_dwordx4 v15, s[48:51], s37 offen offset:2048 sc1 lds
    s_waitcnt vmcnt(15)
    ds_read_b128 a[64:67], v28 offset:17408
    ds_read_b128 a[68:71], v29 offset:17408
    ds_read_b128 a[72:75], v28 offset:17472
    ds_read_b128 a[76:79], v29 offset:17472
    ds_read_b128 a[80:83], v28 offset:17536
    ds_read_b128 a[84:87], v29 offset:17536
    ds_read_b128 a[88:91], v28 offset:17600
    ds_read_b128 a[92:95], v29 offset:17600
    s_add_u32 m0, s27, 129024
    s_nop 0
    buffer_load_dwordx4 v15, s[48:51], s38 offen offset:0 sc1 lds
    buffer_load_dwordx4 v15, s[48:51], s38 offen offset:1024 sc1 lds
    buffer_load_dwordx4 v15, s[48:51], s38 offen offset:2048 sc1 lds
    s_add_u32 m0, s27, 141312
    s_nop 0
    buffer_load_dwordx4 v15, s[48:51], s39 offen offset:0 sc1 lds
    buffer_load_dwordx4 v15, s[48:51], s39 offen offset:1024 sc1 lds
    buffer_load_dwordx4 v15, s[48:51], s39 offen offset:2048 sc1 lds
    s_waitcnt vmcnt(12)
L_votesX:
    v_mov_b32 v31, 0
    v_xor_b32 v246, s100, v246
    v_xor_b32 v247, s100, v247
    v_cmp_eq_u32 s[64:65], 1, v246
    v_cmp_eq_u32 s[66:67], 1, v247
    v_or_b32 v246, v246, v247
    v_and_or_b32 v31, v246, -2, v31
    v_cmp_ne_u32 vcc, 0, v31
    s_mov_b32 s68, 0x55555555
    s_mov_b32 s69, 0x55555555
    s_and_b64 s[70:71], s[64:65], s[68:69]
    s_bcnt1_i32_b64 s8, s[70:71]
    s_and_b64 s[70:71], s[66:67], s[68:69]
    s_bcnt1_i32_b64 s9, s[70:71]
    s_andn2_b64 s[70:71], s[64:65], s[68:69]
    s_bcnt1_i32_b64 s10, s[70:71]
    s_andn2_b64 s[70:71], s[66:67], s[68:69]
    s_bcnt1_i32_b64 s11, s[70:71]
    s_bcnt1_i32_b64 s70, s[64:65]
    s_bcnt1_i32_b64 s71, s[66:67]
    s_cmp_gt_u32 s70, s71
    s_cselect_b32 s70, 12, 19
    s_cselect_b32 s71, 19, 12
    s_cmp_gt_u32 s8, s70
    s_cselect_b32 s8, 0x2000, 0
    s_cmp_gt_u32 s9, s71
    s_cselect_b32 s9, 0x2000, 0
    s_cmp_gt_u32 s10, s70
    s_cselect_b32 s10, 0x2000, 0
    s_cmp_gt_u32 s11, s71
    s_cselect_b32 s11, 0x2000, 0
    s_cbranch_vccnz L_retryVX
    v_xor_b32 v13, s9, v13
    v_xor_b32 v249, s8, v249
L_S:
    v_mov_b32 v31, 0
    s_waitcnt vmcnt(9)
    s_barrier
    ds_read_b128 v[64:67], v16 offset:0
    ds_read_b128 v[68:71], v17 offset:0
    ds_read_b128 v[72:75], v18 offset:0
    ds_read_b128 v[76:79], v19 offset:0
    ds_read_b128 v[80:83], v20 offset:0
    ds_read_b128 v[84:87], v21 offset:0
    s_waitcnt lgkmcnt(3)
    v_add3_u32 v64, v64, v69, v75
    v_mov_b32 v69, v65
    ds_read_b128 v[88:91], v22 offset:0
    v_mfma_f32_32x32x16_bf16 v[32:47], a[4:7], v[70:73], 0
    v_bitop3_b32 v31, v31, v64, s99 bitop3:0xf6
    buffer_load_dwordx4 v[112:115], v14, s[52:55], s40 offen offset:0
    ds_read_b128 v[92:95], v23 offset:0
    ds_read_b128 v[96:99], v24 offset:0
    v_mfma_f32_32x32x16_bf16 v[32:47], a[0:3], v[66:69], v[32:47]
    s_waitcnt lgkmcnt(3)
    v_add3_u32 v76, v76, v81, v87
    v_mov_b32 v81, v77
    ds_read_b128 v[100:103], v25 offset:0
    v_mfma_f32_32x32x16_bf16 v[32:47], a[12:15], v[82:85], v[32:47]
    v_bitop3_b32 v31, v31, v76, s99 bitop3:0xf6
    buffer_load_dwordx4 v[116:119], v14, s[52:55], s40 offen offset:1024
    ds_read_b128 v[104:107], v26 offset:0
    ds_read_b128 v[108:111], v27 offset:0
    v_mfma_f32_32x32x16_bf16 v[32:47], a[8:11], v[78:81], v[32:47]
    s_waitcnt lgkmcnt(3)
    v_add3_u32 v88, v88, v93, v99
    v_mov_b32 v93, v89
    s_waitcnt vmcnt(8)
    s_barrier
    ds_read_b128 v[64:67], v16 offset:12288
    v_mfma_f32_32x32x16_bf16 v[32:47], a[20:23], v[94:97], v[32:47]
    v_bitop3_b32 v31, v31, v88, s99 bitop3:0xf6
    buffer_load_dwordx4 v[120:123], v14, s[52:55], s40 offen offset:2048
    ds_read_b128 v[68:71], v17 offset:12288
    ds_read_b128 v[72:75], v18 offset:12288
    v_mfma_f32_32x32x16_bf16 v[32:47], a[16:19], v[90:93], v[32:47]
    s_waitcnt lgkmcnt(3)
    v_add3_u32 v100, v100, v105, v111
    v_mov_b32 v105, v101
    ds_read_b128 v[76:79], v19 offset:12288
    v_mfma_f32_32x32x16_bf16 v[32:47], a[28:31], v[106:109], v[32:47]
    v_bitop3_b32 v31, v31, v100, s99 bitop3:0xf6
    buffer_load_dwordx4 v[124:127], v14, s[52:55], s40 offen offset:3072
    ds_read_b128 v[80:83], v20 offset:12288
    ds_read_b128 v[84:87], v21 offset:12288
    v_mfma_f32_32x32x16_bf16 v[32:47], a[24:27], v[102:105], v[32:47]
    s_waitcnt lgkmcnt(3)
    v_add3_u32 v64, v64, v69, v75
    v_mov_b32 v69, v65
    ds_read_b128 a[96:99], v28 offset:0
    ds_read_b128 v[88:91], v22 offset:12288
    v_mfma_f32_32x32x16_bf16 v[32:47], a[36:39], v[70:73], v[32:47]
    v_bitop3_b32 v31, v31, v64, s99 bitop3:0xf6
    buffer_load_dwordx4 v[128:131], v14, s[52:55], s41 offen offset:0
    ds_read_b128 v[92:95], v23 offset:12288
    ds_read_b128 v[96:99], v24 offset:12288
    v_mfma_f32_32x32x16_bf16 v[32:47], a[32:35], v[66:69], v[32:47]
    s_waitcnt lgkmcnt(4)
    v_add3_u32 v76, v76, v81, v87
    v_mov_b32 v81, v77
    ds_read_b128 a[100:103], v29 offset:0
    ds_read_b128 v[100:103], v25 offset:12288
    v_mfma_f32_32x32x16_bf16 v[32:47], a[44:47], v[82:85], v[32:47]
    v_bitop3_b32 v31, v31, v76, s99 bitop3:0xf6
    buffer_load_dwordx4 v[132:135], v14, s[52:55], s41 offen offset:1024
    ds_read_b128 v[104:107], v26 offset:12288
    ds_read_b128 v[108:111], v27 offset:12288
    v_mfma_f32_32x32x16_bf16 v[32:47], a[40:43], v[78:81], v[32:47]
    s_waitcnt lgkmcnt(4)
    v_add3_u32 v88, v88, v93, v99
    v_mov_b32 v93, v89
    ds_read_b128 a[104:107], v28 offset:64
    s_waitcnt vmcnt(9)
    s_barrier
    ds_read_b128 v[64:67], v16 offset:24576
    v_mfma_f32_32x32x16_bf16 v[32:47], a[52:55], v[94:97], v[32:47]
    v_bitop3_b32 v31, v31, v88, s99 bitop3:0xf6
    ds_read_b128 v[68:71], v17 offset:24576
    ds_read_b128 v[72:75], v18 offset:24576
    v_mfma_f32_32x32x16_bf16 v[32:47], a[48:51], v[90:93], v[32:47]
    s_waitcnt lgkmcnt(4)
    v_add3_u32 v100, v100, v105, v111
    v_mov_b32 v105, v101
    ds_read_b128 a[108:111], v29 offset:64
    ds_read_b128 v[76:79], v19 offset:24576
    v_mfma_f32_32x32x16_bf16 v[32:47], a[60:63], v[106:109], v[32:47]
    v_bitop3_b32 v31, v31, v100, s99 bitop3:0xf6
    ds_read_b128 v[80:83], v20 offset:24576
    ds_read_b128 v[84:87], v21 offset:24576
    v_mfma_f32_32x32x16_bf16 v[32:47], a[56:59], v[102:105], v[32:47]
    s_waitcnt lgkmcnt(4)
    v_add3_u32 v64, v64, v69, v75
    v_mov_b32 v69, v65
    ds_read_b128 a[112:115], v28 offset:128
    ds_read_b128 v[88:91], v22 offset:24576
    v_mfma_f32_32x32x16_bf16 v[32:47], a[68:71], v[70:73], v[32:47]
    v_bitop3_b32 v31, v31, v64, s99 bitop3:0xf6
    ds_read_b128 v[92:95], v23 offset:24576
    ds_read_b128 v[96:99], v24 offset:24576
    v_mfma_f32_32x32x16_bf16 v[32:47], a[64:67], v[66:69], v[32:47]
    s_waitcnt lgkmcnt(4)
    v_add3_u32 v76, v76, v81, v87
    v_mov_b32 v81, v77
    ds_read_b128 a[116:119], v29 offset:128
    ds_read_b128 v[100:103], v25 offset:24576
    v_mfma_f32_32x32x16_bf16 v[32:47], a[76:79], v[82:85], v[32:47]
    v_bitop3_b32 v31, v31, v76, s99 bitop3:0xf6
    ds_read_b128 v[104:107], v26 offset:24576
    ds_read_b128 v[108:111], v27 offset:24576
    v_mfma_f32_32x32x16_bf16 v[32:47], a[72:75], v[78:81], v[32:47]
    s_waitcnt lgkmcnt(4)
    v_add3_u32 v88, v88, v93, v99
    v_mov_b32 v93, v89
    ds_read_b128 a[120:123], v28 offset:192
    s_waitcnt vmcnt(6)
    s_barrier
    ds_read_b128 v[64:67], v16 offset:36864
    v_mfma_f32_32x32x16_bf16 v[32:47], a[84:87], v[94:97], v[32:47]
    v_bitop3_b32 v31, v31, v88, s99 bitop3:0xf6
    ds_read_b128 v[68:71], v17 offset:36864
    ds_read_b128 v[72:75], v18 offset:36864
    v_mfma_f32_32x32x16_bf16 v[32:47], a[80:83], v[90:93], v[32:47]
    s_waitcnt lgkmcnt(4)
    v_add3_u32 v100, v100, v105, v111
    v_mov_b32 v105, v101
    ds_read_b128 a[124:127], v29 offset:192
    ds_read_b128 v[76:79], v19 offset:36864
    v_mfma_f32_32x32x16_bf16 v[32:47], a[92:95], v[106:109], v[32:47]
    v_bitop3_b32 v31, v31, v100, s99 bitop3:0xf6
    ds_read_b128 v[80:83], v20 offset:36864
    ds_read_b128 v[84:87], v21 offset:36864
    v_mfma_f32_32x32x16_bf16 v[32:47], a[88:91], v[102:105], v[32:47]
    s_waitcnt lgkmcnt(4)
    v_add3_u32 v64, v64, v69, v75
    v_mov_b32 v69, v65
    ds_read_b128 v[88:91], v22 offset:36864
    v_mfma_f32_32x32x16_bf16 v[32:47], a[100:103], v[70:73], v[32:47]
    v_bitop3_b32 v31, v31, v64, s99 bitop3:0xf6
    ds_read_b128 v[92:95], v23 offset:36864
    ds_read_b128 v[96:99], v24 offset:36864
    v_mfma_f32_32x32x16_bf16 v[32:47], a[96:99], v[66:69], v[32:47]
    s_waitcnt lgkmcnt(3)
    v_add3_u32 v76, v76, v81, v87
    v_mov_b32 v81, v77
    ds_read_b128 v[100:103], v25 offset:36864
    v_mfma_f32_32x32x16_bf16 v[32:47], a[108:111], v[82:85], v[32:47]
    v_bitop3_b32 v31, v31, v76, s99 bitop3:0xf6
    ds_read_b128 v[104:107], v26 offset:36864
    ds_read_b128 v[108:111], v27 offset:36864
    v_mfma_f32_32x32x16_bf16 v[32:47], a[104:107], v[78:81], v[32:47]
    s_waitcnt lgkmcnt(3)
    v_add3_u32 v88, v88, v93, v99
    v_mov_b32 v93, v89
    v_mfma_f32_32x32x16_bf16 v[32:47], a[116:119], v[94:97], v[32:47]
    v_bitop3_b32 v31, v31, v88, s99 bitop3:0xf6
    v_mfma_f32_32x32x16_bf16 v[32:47], a[112:115], v[90:93], v[32:47]
    s_waitcnt lgkmcnt(0)
    v_add3_u32 v100, v100, v105, v111
    v_mov_b32 v105, v101
    v_mfma_f32_32x32x16_bf16 v[32:47], a[124:127], v[106:109], v[32:47]
    v_bitop3_b32 v31, v31, v100, s99 bitop3:0xf6
    v_mfma_f32_32x32x16_bf16 v[32:47], a[120:123], v[102:105], v[32:47]
    v_cmp_ne_u32 vcc, 0, v31
    v_mov_b32 v64, s100
    v_mov_b32 v69, s100
    v_mov_b32 v75, s100
    s_cbranch_vccnz L_retryQ
    v_cmp_lt_u32 vcc, 31, v1
    s_nop 5
    v_max3_f32 v8, v32, v33, v34
    v_max3_f32 v9, v35, v36, v37
    v_max3_f32 v8, v8, v38, v39
    v_max3_f32 v9, v9, v40, v41
    v_max3_f32 v8, v8, v42, v43
    v_max3_f32 v9, v9, v44, v45
    v_max3_f32 v8, v8, v46, v47
    v_max_f32 v8, v8, v9
    v_mov_b32 v9, v8
    s_nop 1
    v_permlane32_swap_b32 v8, v9
    v_max_f32 v8, v8, v9
    ds_write_b32 v7, v8
    s_waitcnt lgkmcnt(0)
    s_barrier
    ds_read_b128 v[8:11], v6
    s_waitcnt lgkmcnt(0)
    v_max3_f32 v8, v8, v9, v10
    v_max_f32 v8, v8, v11
    v_pk_add_f32 v[32:33], v[32:33], v[8:9] op_sel_hi:[1,0] neg_lo:[0,1] neg_hi:[0,1]
    v_pk_add_f32 v[34:35], v[34:35], v[8:9] op_sel_hi:[1,0] neg_lo:[0,1] neg_hi:[0,1]
    v_exp_f32 v32, v32
    v_exp_f32 v33, v33
    s_nop 0
    v_cvt_pk_bf16_f32 v66, v32, v33
    v_pk_add_f32 v[38:39], v[38:39], v[8:9] op_sel_hi:[1,0] neg_lo:[0,1] neg_hi:[0,1]
    v_exp_f32 v34, v34
    v_exp_f32 v35, v35
    s_nop 0
    v_cvt_pk_bf16_f32 v67, v34, v35
    v_pk_add_f32 v[36:37], v[36:37], v[8:9] op_sel_hi:[1,0] neg_lo:[0,1] neg_hi:[0,1]
    v_exp_f32 v38, v38
    v_exp_f32 v39, v39
    v_pk_add_f32 v[10:11], v[32:33], v[34:35]
    v_cvt_pk_bf16_f32 v65, v38, v39
    buffer_store_dwordx4 v[64:67], v13, s[48:51], 0 offen offset:0 sc1
    v_pk_add_f32 v[40:41], v[40:41], v[8:9] op_sel_hi:[1,0] neg_lo:[0,1] neg_hi:[0,1]
    v_exp_f32 v36, v36
    v_exp_f32 v37, v37
    v_pk_add_f32 v[10:11], v[10:11], v[38:39]
    v_cvt_pk_bf16_f32 v68, v36, v37
    v_pk_add_f32 v[42:43], v[42:43], v[8:9] op_sel_hi:[1,0] neg_lo:[0,1] neg_hi:[0,1]
    v_exp_f32 v40, v40
    v_exp_f32 v41, v41
    v_pk_add_f32 v[10:11], v[10:11], v[36:37]
    v_cvt_pk_bf16_f32 v70, v40, v41
    v_pk_add_f32 v[44:45], v[44:45], v[8:9] op_sel_hi:[1,0] neg_lo:[0,1] neg_hi:[0,1]
    v_exp_f32 v42, v42
    v_exp_f32 v43, v43
    v_pk_add_f32 v[10:11], v[10:11], v[40:41]
    v_cvt_pk_bf16_f32 v71, v42, v43
    buffer_store_dwordx4 v[68:71], v13, s[48:51], 0 offen offset:1024 sc1
    v_pk_add_f32 v[46:47], v[46:47], v[8:9] op_sel_hi:[1,0] neg_lo:[0,1] neg_hi:[0,1]
    v_exp_f32 v44, v44
    v_exp_f32 v45, v45
    v_pk_add_f32 v[10:11], v[10:11], v[42:43]
    v_cvt_pk_bf16_f32 v72, v44, v45
    v_exp_f32 v46, v46
    v_exp_f32 v47, v47
    v_pk_add_f32 v[10:11], v[10:11], v[44:45]
    v_cvt_pk_bf16_f32 v73, v46, v47
    v_pk_add_f32 v[10:11], v[10:11], v[46:47]
    v_add_f32 v9, v10, v11
    v_add_f32 v10, v10, v11
    s_nop 1
    v_permlane32_swap_b32 v9, v10
    v_add_f32 v9, v9, v10
    v_cndmask_b32 v74, v8, v9, vcc
    buffer_store_dwordx4 v[72:75], v13, s[48:51], 0 offen offset:2048 sc1
    s_mov_b64 exec, 15
    buffer_store_dword v248, v249, s[48:51], 0 offen sc1
    s_mov_b64 exec, -1
    s_barrier
    buffer_load_dwordx4 v[136:139], v14, s[52:55], s41 offen offset:2048
    buffer_load_dwordx4 v[140:143], v14, s[52:55], s41 offen offset:3072
    s_mov_b32 s36, s12
    s_and_b32 s37, s13, 0xffff
    s_mov_b32 s38, 0x400000
    s_mov_b32 s39, 0x20000
    s_mov_b32 m0, s3
    s_mov_b32 s56, 0
    buffer_load_dwordx4 v241, s[36:39], s56 offen nt lds
    s_addk_i32 m0, 0x400
    s_add_u32 s56, s56, 0x10000
    buffer_load_dwordx4 v241, s[36:39], s56 offen nt lds
    s_addk_i32 m0, 0x400
    s_add_u32 s56, s56, 0x10000
    buffer_load_dwordx4 v241, s[36:39], s56 offen nt lds
    s_addk_i32 m0, 0x400
    s_add_u32 s56, s56, 0x10000
    buffer_load_dwordx4 v241, s[36:39], s56 offen nt lds
    s_addk_i32 m0, 0x400
    s_add_u32 s56, s56, 0x10000
    buffer_load_dwordx4 v241, s[36:39], s56 offen nt lds
    s_addk_i32 m0, 0x400
    s_add_u32 s56, s56, 0x10000
    buffer_load_dwordx4 v241, s[36:39], s56 offen nt lds
    s_addk_i32 m0, 0x400
    s_add_u32 s56, s56, 0x10000
    buffer_load_dwordx4 v241, s[36:39], s56 offen nt lds
    s_addk_i32 m0, 0x400
    s_add_u32 s56, s56, 0x10000
    buffer_load_dwordx4 v241, s[36:39], s56 offen nt lds
    s_lshl_b32 s34, s63, 1
    s_lshr_b32 s35, s30, 1
    s_add_u32 s34, s34, s35
    s_lshl_b32 s34, s34, 13
    s_xor_b32 s34, s34, s11
    s_add_u32 s34, s34, 6291456
    s_and_b32 s35, s30, 1
    s_mul_i32 s35, s35, 3072
    s_add_u32 s34, s34, s35
    v_lshl_add_u32 v13, v1, 4, s34
    s_mov_b32 s34, s63
    s_lshr_b32 s35, s34, 3
    s_lshl_b32 s35, s35, 4
    s_and_b32 s34, s34, 7
    s_add_u32 s34, s34, s35
    s_lshl_b32 s34, s34, 2
    s_lshl_b32 s35, s30, 13
    s_add_u32 s34, s34, s35
    s_add_u32 s34, s34, 589824
    v_lshl_add_u32 v249, v1, 10, s34
    v_mul_u32_u24 v12, 144, v5
    v_lshl_add_u32 v12, v4, 4, v12
    s_lshl_b32 s34, s17, 6
    s_xor_b32 s35, s34, 64
    s_add_u32 s34, s34, 154624
    s_add_u32 s35, s35, 154624
    v_add_u32 v3, s35, v12
    v_add_u32 v12, s34, v12
    v_lshrrev_b32 v8, 5, v1
    v_bfe_u32 v9, v1, 2, 2
    v_lshl_add_u32 v10, v8, 2, v9
    v_lshl_add_u32 v10, v10, 7, s3
    v_lshrrev_b32 v7, 1, v9
    v_lshl_add_u32 v10, v7, 6, v10
    v_bfe_u32 v7, v1, 4, 1
    v_lshl_add_u32 v10, v7, 5, v10
    v_and_b32 v7, 3, v1
    v_lshl_add_u32 v28, v7, 3, v10
    v_xor_b32 v29, 64, v28
    s_and_b32 s34, s16, 30
    s_add_u32 s34, s34, s17
    s_lshl_b32 s34, s34, 2
    s_add_u32 s34, s34, s30
    s_lshl_b32 s34, s34, 1
    s_lshr_b32 s35, s31, 2
    s_add_u32 s34, s34, s35
    s_lshl_b32 s34, s34, 13
    s_xor_b32 s34, s34, s10
    s_add_u32 s34, s34, 4194304
    s_mul_i32 s26, s30, 6144
    v_lshl_add_u32 v15, v1, 4, s34
    s_add_u32 s26, s26, 104448
    s_and_b32 s33, s16, 1
    s_mul_i32 s33, s33, 3072
    s_xor_b32 s27, s33, 3072
    v_and_b32 v7, 31, v1
    v_mul_u32_u24 v10, 192, v7
    v_add_u32 v10, s26, v10
    v_mul_u32_u24 v11, 6, v8
    v_add_u32 v6, 0, v11
    v_xor_b32 v6, v6, v9
    v_lshl_add_u32 v16, v6, 4, v10
    v_add_u32 v6, 1, v11
    v_xor_b32 v6, v6, v9
    v_lshl_add_u32 v17, v6, 4, v10
    v_add_u32 v6, 2, v11
    v_xor_b32 v6, v6, v9
    v_lshl_add_u32 v18, v6, 4, v10
    v_add_u32 v6, 3, v11
    v_xor_b32 v6, v6, v9
    v_lshl_add_u32 v19, v6, 4, v10
    v_add_u32 v6, 4, v11
    v_xor_b32 v6, v6, v9
    v_lshl_add_u32 v20, v6, 4, v10
    v_add_u32 v6, 5, v11
    v_xor_b32 v6, v6, v9
    v_lshl_add_u32 v21, v6, 4, v10
    s_lshl_b32 s34, s30, 7
    s_add_u32 s34, s34, 161792
    v_lshl_add_u32 v10, v7, 2, s34
    v_lshl_add_u32 v11, v8, 4, s34
    s_mul_i32 s34, s30, 144
    s_add_u32 s34, s34, 154624
    v_lshl_add_u32 v2, v1, 1, s34
    s_and_b32 s57, s31, 4
    s_lshl_b32 s57, s57, 2
    s_add_u32 s57, s57, s32
    s_lshl_b32 s57, s57, 2
    s_add_u32 s57, s57, s30
    s_lshl_b32 s57, s57, 7
    s_xor_b32 s57, s57, s8
    s_mov_b32 s63, s57
    s_mul_i32 s56, s31, 14
    s_add_u32 s56, s56, s32
    s_cmp_ge_u32 s32, 6
    s_cselect_b32 s34, 2, 0
    s_sub_u32 s56, s56, s34
    s_lshr_b32 s34, s32, 1
    s_cmp_eq_u32 s34, 3
    s_cselect_b32 s56, 112, s56
    s_lshl_b32 s34, s56, 14
    s_lshl_b32 s35, s30, 8
    s_add_u32 s34, s34, s35
    v_lshl_add_u32 v242, v4, 12, s34
    v_lshl_add_u32 v242, v5, 4, v242
    s_mov_b32 s44, s22
    s_and_b32 s45, s23, 0xffff
    s_mov_b32 s46, 0x1c0000
    s_mov_b32 s47, 0x20000
    buffer_load_dwordx4 v[64:67], v242, s[44:47], 0 offen offset:0 nt
    buffer_load_dwordx4 v[68:71], v242, s[44:47], 0 offen offset:1024 nt
    buffer_load_dwordx4 v[72:75], v242, s[44:47], 0 offen offset:2048 nt
    buffer_load_dwordx4 v[76:79], v242, s[44:47], 0 offen offset:3072 nt
    s_waitcnt vmcnt(12)
    buffer_load_dwordx4 v[144:147], v14, s[52:55], s42 offen offset:0 nt
    v_perm_b32 v176, v116, v112, s61
    v_perm_b32 v177, v124, v120, s61
    v_perm_b32 v178, v132, v128, s61
    v_perm_b32 v179, v140, v136, s61
    buffer_load_dwordx4 v[148:151], v14, s[52:55], s42 offen offset:1024 nt
    v_perm_b32 v180, v116, v112, s62
    v_perm_b32 v181, v124, v120, s62
    v_perm_b32 v182, v132, v128, s62
    v_perm_b32 v183, v140, v136, s62
    buffer_load_dwordx4 v[152:155], v14, s[52:55], s42 offen offset:2048 nt
    v_perm_b32 v184, v117, v113, s61
    v_perm_b32 v185, v125, v121, s61
    v_perm_b32 v186, v133, v129, s61
    v_perm_b32 v187, v141, v137, s61
    buffer_load_dwordx4 v[156:159], v14, s[52:55], s42 offen offset:3072 nt
    v_perm_b32 v188, v117, v113, s62
    v_perm_b32 v189, v125, v121, s62
    v_perm_b32 v190, v133, v129, s62
    v_perm_b32 v191, v141, v137, s62
    buffer_load_dwordx4 v[160:163], v14, s[52:55], s43 offen offset:0 nt
    v_perm_b32 v192, v118, v114, s61
    v_perm_b32 v193, v126, v122, s61
    v_perm_b32 v194, v134, v130, s61
    v_perm_b32 v195, v142, v138, s61
    buffer_load_dwordx4 v[164:167], v14, s[52:55], s43 offen offset:1024 nt
    v_perm_b32 v196, v118, v114, s62
    v_perm_b32 v197, v126, v122, s62
    v_perm_b32 v198, v134, v130, s62
    v_perm_b32 v199, v142, v138, s62
    buffer_load_dwordx4 v[168:171], v14, s[52:55], s43 offen offset:2048 nt
    v_perm_b32 v200, v119, v115, s61
    v_perm_b32 v201, v127, v123, s61
    v_perm_b32 v202, v135, v131, s61
    v_perm_b32 v203, v143, v139, s61
    buffer_load_dwordx4 v[172:175], v14, s[52:55], s43 offen offset:3072 nt
    v_perm_b32 v204, v119, v115, s62
    v_perm_b32 v205, v127, v123, s62
    v_perm_b32 v206, v135, v131, s62
    v_perm_b32 v207, v143, v139, s62
    s_lshr_b32 s57, s56, 2
    s_lshl_b32 s57, s57, 4
    s_add_u32 s57, s57, s30
    s_lshl_b32 s57, s57, 2
    s_and_b32 s34, s56, 3
    s_add_u32 s57, s57, s34
    s_lshl_b32 s57, s57, 8
    s_add_u32 s34, s57, 851968
    v_lshl_add_u32 v242, v4, 12, s34
    v_lshl_add_u32 v242, v5, 4, v242
    v_lshrrev_b32 v9, 2, v5
    v_mul_u32_u24 v9, 576, v9
    v_and_b32 v6, 1, v5
    v_lshl_add_u32 v9, v6, 4, v9
    s_lshl_b32 s34, s30, 2
    s_add_u32 s34, s34, 157696
    v_add_u32 v9, s34, v9
    v_mul_u32_u24 v243, 144, v5
    v_lshl_add_u32 v243, v4, 3, v243
    v_add_u32 v243, 157696, v243
    s_add_u32 s63, s63, 0x70000
    s_add_u32 s58, s28, s63
    s_addc_u32 s59, s29, 0
    s_add_u32 s57, s57, 851980
    s_add_u32 s40, s28, s57
    s_addc_u32 s41, s29, 0
    v_mov_b32 v99, s100
    v_mov_b32 v103, s100
    v_mov_b32 v107, s100
    v_mov_b32 v106, 0
    s_cmp_ge_u32 s56, 112
    s_cselect_b32 s16, 2, 0
L_pollC:
    s_load_dwordx8 s[64:71], s[58:59], 0x0 glc
    s_load_dwordx8 s[72:79], s[58:59], 0x40 glc
    s_cmp_eq_u32 s16, 3
    s_cbranch_scc1 L_pollCw
    s_bitcmp1_b32 s16, 1
    s_cbranch_scc1 L_pc1
    s_load_dword s80, s[40:41], 0x0 glc
    s_load_dword s81, s[40:41], 0x1000 glc
    s_load_dword s82, s[40:41], 0x2000 glc
    s_load_dword s83, s[40:41], 0x3000 glc
L_pc1:
    s_bitcmp1_b32 s16, 0
    s_cbranch_scc1 L_pc2x
    s_getreg_b32 s34, hwreg(HW_REG_IB_STS)
    s_and_b32 s34, s34, 0xc000000f
    s_cmp_gt_u32 s34, 8
    s_cbranch_scc1 L_pc2x
    s_waitcnt vmcnt(8)
    ds_read_b64_tr_b16 a[0:1], v28 offset:0
    v_perm_b32 v80, v68, v64, s61
    ds_read_b64_tr_b16 a[2:3], v28 offset:1024
    v_perm_b32 v81, v76, v72, s61
    ds_read_b64_tr_b16 a[4:5], v29 offset:0
    v_perm_b32 v82, v68, v64, s62
    ds_read_b64_tr_b16 a[6:7], v29 offset:1024
    v_perm_b32 v83, v76, v72, s62
    ds_read_b64_tr_b16 a[8:9], v28 offset:2048
    v_perm_b32 v84, v69, v65, s61
    ds_read_b64_tr_b16 a[10:11], v28 offset:3072
    v_perm_b32 v85, v77, v73, s61
    ds_read_b64_tr_b16 a[12:13], v29 offset:2048
    v_perm_b32 v86, v69, v65, s62
    ds_read_b64_tr_b16 a[14:15], v29 offset:3072
    v_perm_b32 v87, v77, v73, s62
    ds_read_b64_tr_b16 a[16:17], v28 offset:4096
    v_perm_b32 v88, v70, v66, s61
    ds_read_b64_tr_b16 a[18:19], v28 offset:5120
    v_perm_b32 v89, v78, v74, s61
    ds_read_b64_tr_b16 a[20:21], v29 offset:4096
    v_perm_b32 v90, v70, v66, s62
    ds_read_b64_tr_b16 a[22:23], v29 offset:5120
    v_perm_b32 v91, v78, v74, s62
    ds_read_b64_tr_b16 a[24:25], v28 offset:6144
    v_perm_b32 v92, v71, v67, s61
    ds_read_b64_tr_b16 a[26:27], v28 offset:7168
    v_perm_b32 v93, v79, v75, s61
    ds_read_b64_tr_b16 a[28:29], v29 offset:6144
    v_perm_b32 v94, v71, v67, s62
    ds_read_b64_tr_b16 a[30:31], v29 offset:7168
    v_perm_b32 v95, v79, v75, s62
    s_or_b32 s16, s16, 1
L_pc2x:
    s_bitcmp1_b32 s16, 1
    s_cbranch_scc1 L_pollCw
    s_waitcnt lgkmcnt(0)
    s_xor_b64 s[80:81], s[80:81], s[100:101]
    s_xor_b64 s[82:83], s[82:83], s[100:101]
    s_or_b64 s[80:81], s[80:81], s[82:83]
    s_cbranch_scc1 L_pollCw
    buffer_load_dwordx4 v[32:35], v242, s[48:51], 0 offen sc1
    s_or_b32 s16, s16, 2
L_pollCw:
    s_add_u32 s60, s60, 1
    s_cmp_gt_u32 s60, 262144
    s_cbranch_scc1 L_exit
    s_waitcnt lgkmcnt(0)
    s_xor_b64 s[64:65], s[64:65], s[100:101]
    s_xor_b64 s[66:67], s[66:67], s[100:101]
    s_xor_b64 s[68:69], s[68:69], s[100:101]
    s_xor_b64 s[70:71], s[70:71], s[100:101]
    s_xor_b64 s[72:73], s[72:73], s[100:101]
    s_xor_b64 s[74:75], s[74:75], s[100:101]
    s_xor_b64 s[76:77], s[76:77], s[100:101]
    s_xor_b64 s[78:79], s[78:79], s[100:101]
    s_or_b64 s[64:65], s[64:65], s[72:73]
    s_or_b64 s[66:67], s[66:67], s[74:75]
    s_or_b64 s[68:69], s[68:69], s[76:77]
    s_or_b64 s[70:71], s[70:71], s[78:79]
    s_or_b64 s[64:65], s[64:65], s[68:69]
    s_or_b64 s[66:67], s[66:67], s[70:71]
    s_or_b64 s[64:65], s[64:65], s[66:67]
    s_cbranch_scc1 L_pollC
    s_bitcmp1_b32 s16, 1
    s_cbranch_scc1 L_pc3
    buffer_load_dwordx4 v[32:35], v242, s[48:51], 0 offen sc1
L_pc3:
    s_barrier
    s_add_u32 m0, s26, s33
    s_nop 0
    buffer_load_dwordx4 v15, s[48:51], s33 offen offset:0 sc1 lds
    buffer_load_dwordx4 v15, s[48:51], s33 offen offset:1024 sc1 lds
    buffer_load_dwordx4 v15, s[48:51], s33 offen offset:2048 sc1 lds
    s_add_u32 m0, s26, s27
    s_nop 0
    buffer_load_dwordx4 v15, s[48:51], s27 offen offset:0 sc1 lds
    buffer_load_dwordx4 v15, s[48:51], s27 offen offset:1024 sc1 lds
    buffer_load_dwordx4 v15, s[48:51], s27 offen offset:2048 sc1 lds
    s_bitcmp1_b32 s16, 0
    s_cbranch_scc0 L_late
L_prepped:
    s_waitcnt vmcnt(6)
    s_cmp_ge_u32 s56, 112
    s_cbranch_scc1 L_noF
L_H:
    v_cmp_ne_u32 vcc, s100, v35
    v_mov_b64 v[34:35], v[32:33]
    s_cbranch_vccnz L_retryH
    s_nop 0
    v_permlane32_swap_b32 v32, v34
    v_permlane32_swap_b32 v33, v35
    v_pk_add_f32 v[32:33], v[32:33], v[34:35]
    v_mov_b64 v[34:35], v[32:33]
    s_nop 1
    v_permlane16_swap_b32 v32, v34
    v_permlane16_swap_b32 v33, v35
    v_pk_add_f32 v[32:33], v[32:33], v[34:35]
    v_mul_f32 v34, v32, v32
    v_mul_f32 v35, v33, v33
    v_mul_f32 v34, 0x3d372713, v34
    v_mul_f32 v35, 0x3d372713, v35
    v_fma_f32 v34, v34, v32, v32
    v_fma_f32 v35, v35, v33, v33
    v_mul_f32 v34, 0xc0135761, v34
    v_mul_f32 v35, 0xc0135761, v35
    v_exp_f32 v34, v34
    v_exp_f32 v35, v35
    v_add_f32 v34, 1.0, v34
    v_add_f32 v35, 1.0, v35
    v_rcp_f32 v34, v34
    v_rcp_f32 v35, v35
    v_mul_f32 v34, v32, v34
    v_mul_f32 v35, v33, v35
    s_nop 0
    v_mul_f32_dpp v36, v32, v34 quad_perm:[2,3,0,1] row_mask:0xf bank_mask:0xf
    v_mul_f32_dpp v37, v33, v35 quad_perm:[2,3,0,1] row_mask:0xf bank_mask:0xf
    v_cvt_pk_bf16_f32 v32, v36, v37
    s_mov_b64 exec, 0x3333
    ds_write_b32 v9, v32
    s_mov_b64 exec, -1
    v_and_b32 v9, 3, v5
    v_cmp_eq_u32 vcc, 0, v9
    v_perm_b32 v208, v148, v144, s61
    v_perm_b32 v209, v156, v152, s61
    v_perm_b32 v210, v164, v160, s61
    v_perm_b32 v211, v172, v168, s61
    v_perm_b32 v212, v148, v144, s62
    v_perm_b32 v213, v156, v152, s62
    v_perm_b32 v214, v164, v160, s62
    v_perm_b32 v215, v172, v168, s62
    v_perm_b32 v216, v149, v145, s61
    v_perm_b32 v217, v157, v153, s61
    v_perm_b32 v218, v165, v161, s61
    v_perm_b32 v219, v173, v169, s61
    v_perm_b32 v220, v149, v145, s62
    v_perm_b32 v221, v157, v153, s62
    v_perm_b32 v222, v165, v161, s62
    v_perm_b32 v223, v173, v169, s62
    s_waitcnt lgkmcnt(0)
    s_barrier
    ds_read_b64 v[32:33], v243
    v_perm_b32 v224, v150, v146, s61
    v_perm_b32 v225, v158, v154, s61
    v_perm_b32 v226, v166, v162, s61
    v_perm_b32 v227, v174, v170, s61
    v_perm_b32 v228, v150, v146, s62
    v_perm_b32 v229, v158, v154, s62
    v_perm_b32 v230, v166, v162, s62
    v_perm_b32 v231, v174, v170, s62
    v_perm_b32 v232, v151, v147, s61
    v_perm_b32 v233, v159, v155, s61
    v_perm_b32 v234, v167, v163, s61
    v_perm_b32 v235, v175, v171, s61
    v_perm_b32 v236, v151, v147, s62
    v_perm_b32 v237, v159, v155, s62
    v_perm_b32 v238, v167, v163, s62
    v_perm_b32 v239, v175, v171, s62
    s_waitcnt lgkmcnt(0)
    v_cndmask_b32 v32, 0, v32, vcc
    v_cndmask_b32 v33, 0, v33, vcc
    s_nop 1
    v_mfma_f32_16x16x16_bf16 v[128:131], v[32:33], v[80:81], 0
    v_mfma_f32_16x16x16_bf16 v[132:135], v[32:33], v[82:83], 0
    v_mfma_f32_16x16x16_bf16 v[136:139], v[32:33], v[84:85], 0
    v_mfma_f32_16x16x16_bf16 v[140:143], v[32:33], v[86:87], 0
    v_mfma_f32_16x16x16_bf16 v[144:147], v[32:33], v[88:89], 0
    v_mfma_f32_16x16x16_bf16 v[148:151], v[32:33], v[90:91], 0
    v_mfma_f32_16x16x16_bf16 v[152:155], v[32:33], v[92:93], 0
    v_mfma_f32_16x16x16_bf16 v[156:159], v[32:33], v[94:95], 0
L_C:
    v_mov_b32 v31, 0
    s_waitcnt vmcnt(0)
    ds_read_b128 v[72:75], v18
    ds_read_b128 v[68:71], v17
    ds_read_b128 v[64:67], v16
    ds_read_b128 v[84:87], v21
    ds_read_b128 v[80:83], v20
    ds_read_b128 v[76:79], v19
    s_waitcnt lgkmcnt(5)
    v_mov_b32 v6, v74
    s_waitcnt lgkmcnt(4)
    v_mfma_f32_32x32x16_bf16 v[32:47], v[70:73], a[8:11], 0
    v_permlane32_swap_b32 v6, v74
    s_waitcnt lgkmcnt(3)
    v_add3_u32 v64, v64, v69, v75
    v_max_f32_dpp v8, v6, v6 quad_perm:[1,0,3,2] row_mask:0xf bank_mask:0xf
    v_mov_b32 v69, v65
    v_bitop3_b32 v31, v31, v64, s99 bitop3:0xf6
    v_max_f32_dpp v8, v8, v8 quad_perm:[2,3,0,1] row_mask:0xf bank_mask:0xf
    v_mfma_f32_32x32x16_bf16 v[32:47], v[66:69], a[0:3], v[32:47]
    s_waitcnt lgkmcnt(0)
    v_max_f32_dpp v8, v8, v8 row_half_mirror row_mask:0xf bank_mask:0xf
    v_sub_f32 v6, v6, v8
    v_exp_f32 v6, v6
    v_add3_u32 v76, v76, v81, v87
    v_mul_f32 v7, v6, v74
    v_mfma_f32_32x32x16_bf16 v[32:47], v[82:85], a[24:27], v[32:47]
    v_mov_b32 v81, v77
    v_add_f32_dpp v7, v7, v7 quad_perm:[1,0,3,2] row_mask:0xf bank_mask:0xf
    v_bitop3_b32 v31, v31, v76, s99 bitop3:0xf6
    v_cmp_ne_u32 vcc, 0, v31
    v_add_f32_dpp v7, v7, v7 quad_perm:[2,3,0,1] row_mask:0xf bank_mask:0xf
    v_mfma_f32_32x32x16_bf16 v[32:47], v[78:81], a[16:19], v[32:47]
    s_cbranch_vccnz L_retryC
    v_add_f32_dpp v7, v7, v7 row_half_mirror row_mask:0xf bank_mask:0xf
    v_rcp_f32 v7, v7
    s_nop 0
    v_mul_f32 v6, v6, v7
    ds_write_b32 v10, v6
    v_mfma_f32_32x32x16_bf16 v[48:63], v[70:73], a[12:15], 0
    ds_read_b128 v[112:115], v11 offset:0
    ds_read_b128 v[116:119], v11 offset:32
    ds_read_b128 v[120:123], v11 offset:64
    ds_read_b128 v[124:127], v11 offset:96
    v_mfma_f32_32x32x16_bf16 v[48:63], v[66:69], a[4:7], v[48:63]
    v_mfma_f32_32x32x16_bf16 v[48:63], v[82:85], a[28:31], v[48:63]
    s_waitcnt lgkmcnt(0)
    v_mul_f32 v88, v112, v32
    v_mul_f32 v89, v116, v36
    v_mul_f32 v90, v120, v40
    v_mul_f32 v91, v124, v44
    v_mfma_f32_32x32x16_bf16 v[48:63], v[78:81], a[20:23], v[48:63]
    v_fmac_f32 v88, v113, v33
    v_fmac_f32 v89, v117, v37
    v_fmac_f32 v90, v121, v41
    v_fmac_f32 v91, v125, v45
    v_fmac_f32 v88, v114, v34
    v_fmac_f32 v89, v118, v38
    v_fmac_f32 v90, v122, v42
    v_fmac_f32 v91, v126, v46
    v_fmac_f32 v88, v115, v35
    v_fmac_f32 v89, v119, v39
    v_fmac_f32 v90, v123, v43
    v_fmac_f32 v91, v127, v47
    v_pk_mul_f32 v[72:73], v[112:113], v[48:49]
    v_pk_mul_f32 v[74:75], v[116:117], v[52:53]
    v_pk_mul_f32 v[76:77], v[120:121], v[56:57]
    v_pk_mul_f32 v[78:79], v[124:125], v[60:61]
    v_pk_fma_f32 v[72:73], v[114:115], v[50:51], v[72:73]
    v_pk_fma_f32 v[74:75], v[118:119], v[54:55], v[74:75]
    v_pk_fma_f32 v[76:77], v[122:123], v[58:59], v[76:77]
    v_pk_fma_f32 v[78:79], v[126:127], v[62:63], v[78:79]
    v_add_f32 v92, v72, v73
    v_add_f32 v93, v74, v75
    v_add_f32 v94, v76, v77
    v_add_f32 v95, v78, v79
    v_permlane32_swap_b32 v88, v92
    v_permlane32_swap_b32 v89, v93
    v_permlane32_swap_b32 v90, v94
    v_permlane32_swap_b32 v91, v95
    v_pk_add_f32 v[64:65], v[88:89], v[92:93]
    v_pk_add_f32 v[66:67], v[90:91], v[94:95]
    v_cvt_pk_bf16_f32 v64, v64, v65
    v_cvt_pk_bf16_f32 v66, v66, v67
    ds_write_b16 v2, v64
    ds_write_b16_d16_hi v2, v64 offset:576
    ds_write_b16 v2, v66 offset:1152
    ds_write_b16_d16_hi v2, v66 offset:1728
    s_mov_b64 exec, 255
    buffer_store_dword v248, v249, s[48:51], 0 offen sc1
    s_mov_b64 exec, -1
    s_waitcnt lgkmcnt(0)
    s_barrier
    ds_read_b128 v[72:75], v12
    ds_read_b128 v[76:79], v3
    s_waitcnt lgkmcnt(1)
    v_mfma_f32_16x16x32_bf16 v[128:131], v[72:75], v[176:179], v[128:131]
    s_waitcnt lgkmcnt(0)
    v_mfma_f32_16x16x32_bf16 v[128:131], v[76:79], v[208:211], v[128:131]
    v_mfma_f32_16x16x32_bf16 v[132:135], v[72:75], v[180:183], v[132:135]
    v_mfma_f32_16x16x32_bf16 v[132:135], v[76:79], v[212:215], v[132:135]
    v_mfma_f32_16x16x32_bf16 v[136:139], v[72:75], v[184:187], v[136:139]
    v_mfma_f32_16x16x32_bf16 v[136:139], v[76:79], v[216:219], v[136:139]
    v_mfma_f32_16x16x32_bf16 v[140:143], v[72:75], v[188:191], v[140:143]
    s_nop 2
    v_add_f32 v128, v128, v129
    v_add_f32 v130, v130, v131
    v_mfma_f32_16x16x32_bf16 v[140:143], v[76:79], v[220:223], v[140:143]
    v_add_f32 v96, v128, v130
    v_mfma_f32_16x16x32_bf16 v[144:147], v[72:75], v[192:195], v[144:147]
    v_add_f32 v132, v132, v133
    v_add_f32 v134, v134, v135
    v_mfma_f32_16x16x32_bf16 v[144:147], v[76:79], v[224:227], v[144:147]
    v_add_f32 v97, v132, v134
    v_mfma_f32_16x16x32_bf16 v[148:151], v[72:75], v[196:199], v[148:151]
    v_add_f32 v136, v136, v137
    v_add_f32 v138, v138, v139
    v_mfma_f32_16x16x32_bf16 v[148:151], v[76:79], v[228:231], v[148:151]
    v_add_f32 v98, v136, v138
    buffer_store_dwordx4 v[96:99], v13, s[48:51], 0 offen offset:0 sc1
    v_mfma_f32_16x16x32_bf16 v[152:155], v[72:75], v[200:203], v[152:155]
    v_add_f32 v140, v140, v141
    v_add_f32 v142, v142, v143
    v_mfma_f32_16x16x32_bf16 v[152:155], v[76:79], v[232:235], v[152:155]
    v_add_f32 v100, v140, v142
    v_mfma_f32_16x16x32_bf16 v[156:159], v[72:75], v[204:207], v[156:159]
    v_add_f32 v144, v144, v145
    v_add_f32 v146, v146, v147
    v_mfma_f32_16x16x32_bf16 v[156:159], v[76:79], v[236:239], v[156:159]
    v_add_f32 v101, v144, v146
    v_add_f32 v148, v148, v149
    v_add_f32 v150, v150, v151
    v_add_f32 v102, v148, v150
    buffer_store_dwordx4 v[100:103], v13, s[48:51], 0 offen offset:1024 sc1
    v_add_f32 v152, v152, v153
    v_add_f32 v154, v154, v155
    v_add_f32 v104, v152, v154
    v_add_f32 v156, v156, v157
    v_add_f32 v158, v158, v159
    v_add_f32 v105, v156, v158
    buffer_store_dwordx4 v[104:107], v13, s[48:51], 0 offen offset:2048 sc1
    s_lshl_b32 s34, s30, 8
    s_add_u32 s34, s34, s2
    s_cmp_lg_u32 s34, 8
    s_cbranch_scc1 L_exit
    v_mov_b32 v6, 0
    s_mov_b64 exec, 1
    buffer_store_dword v248, v6, s[48:51], 0 offen sc1
    s_branch L_exit
L_retryC:
    s_add_u32 s60, s60, 1
    s_cmp_gt_u32 s60, 262144
    s_cbranch_scc1 L_exit
    s_add_u32 m0, s26, s33
    s_nop 0
    buffer_load_dwordx4 v15, s[48:51], s33 offen offset:0 sc1 lds
    buffer_load_dwordx4 v15, s[48:51], s33 offen offset:1024 sc1 lds
    buffer_load_dwordx4 v15, s[48:51], s33 offen offset:2048 sc1 lds
    s_add_u32 m0, s26, s27
    s_nop 0
    buffer_load_dwordx4 v15, s[48:51], s27 offen offset:0 sc1 lds
    buffer_load_dwordx4 v15, s[48:51], s27 offen offset:1024 sc1 lds
    buffer_load_dwordx4 v15, s[48:51], s27 offen offset:2048 sc1 lds
    s_waitcnt vmcnt(0)
    s_branch L_C
L_late:
    s_waitcnt vmcnt(14)
    ds_read_b64_tr_b16 a[0:1], v28 offset:0
    v_perm_b32 v80, v68, v64, s61
    ds_read_b64_tr_b16 a[2:3], v28 offset:1024
    v_perm_b32 v81, v76, v72, s61
    ds_read_b64_tr_b16 a[4:5], v29 offset:0
    v_perm_b32 v82, v68, v64, s62
    ds_read_b64_tr_b16 a[6:7], v29 offset:1024
    v_perm_b32 v83, v76, v72, s62
    ds_read_b64_tr_b16 a[8:9], v28 offset:2048
    v_perm_b32 v84, v69, v65, s61
    ds_read_b64_tr_b16 a[10:11], v28 offset:3072
    v_perm_b32 v85, v77, v73, s61
    ds_read_b64_tr_b16 a[12:13], v29 offset:2048
    v_perm_b32 v86, v69, v65, s62
    ds_read_b64_tr_b16 a[14:15], v29 offset:3072
    v_perm_b32 v87, v77, v73, s62
    ds_read_b64_tr_b16 a[16:17], v28 offset:4096
    v_perm_b32 v88, v70, v66, s61
    ds_read_b64_tr_b16 a[18:19], v28 offset:5120
    v_perm_b32 v89, v78, v74, s61
    ds_read_b64_tr_b16 a[20:21], v29 offset:4096
    v_perm_b32 v90, v70, v66, s62
    ds_read_b64_tr_b16 a[22:23], v29 offset:5120
    v_perm_b32 v91, v78, v74, s62
    ds_read_b64_tr_b16 a[24:25], v28 offset:6144
    v_perm_b32 v92, v71, v67, s61
    ds_read_b64_tr_b16 a[26:27], v28 offset:7168
    v_perm_b32 v93, v79, v75, s61
    ds_read_b64_tr_b16 a[28:29], v29 offset:6144
    v_perm_b32 v94, v71, v67, s62
    ds_read_b64_tr_b16 a[30:31], v29 offset:7168
    v_perm_b32 v95, v79, v75, s62
    s_branch L_prepped
L_noF:
    v_perm_b32 v208, v148, v144, s61
    v_perm_b32 v209, v156, v152, s61
    v_perm_b32 v210, v164, v160, s61
    v_perm_b32 v211, v172, v168, s61
    v_perm_b32 v212, v148, v144, s62
    v_perm_b32 v213, v156, v152, s62
    v_perm_b32 v214, v164, v160, s62
    v_perm_b32 v215, v172, v168, s62
    v_perm_b32 v216, v149, v145, s61
    v_perm_b32 v217, v157, v153, s61
    v_perm_b32 v218, v165, v161, s61
    v_perm_b32 v219, v173, v169, s61
    v_perm_b32 v220, v149, v145, s62
    v_perm_b32 v221, v157, v153, s62
    v_perm_b32 v222, v165, v161, s62
    v_perm_b32 v223, v173, v169, s62
    v_perm_b32 v224, v150, v146, s61
    v_perm_b32 v225, v158, v154, s61
    v_perm_b32 v226, v166, v162, s61
    v_perm_b32 v227, v174, v170, s61
    v_perm_b32 v228, v150, v146, s62
    v_perm_b32 v229, v158, v154, s62
    v_perm_b32 v230, v166, v162, s62
    v_perm_b32 v231, v174, v170, s62
    v_perm_b32 v232, v151, v147, s61
    v_perm_b32 v233, v159, v155, s61
    v_perm_b32 v234, v167, v163, s61
    v_perm_b32 v235, v175, v171, s61
    v_perm_b32 v236, v151, v147, s62
    v_perm_b32 v237, v159, v155, s62
    v_perm_b32 v238, v167, v163, s62
    v_perm_b32 v239, v175, v171, s62
    v_mov_b64 v[128:129], 0
    v_mov_b64 v[130:131], 0
    v_mov_b64 v[132:133], 0
    v_mov_b64 v[134:135], 0
    v_mov_b64 v[136:137], 0
    v_mov_b64 v[138:139], 0
    v_mov_b64 v[140:141], 0
    v_mov_b64 v[142:143], 0
    v_mov_b64 v[144:145], 0
    v_mov_b64 v[146:147], 0
    v_mov_b64 v[148:149], 0
    v_mov_b64 v[150:151], 0
    v_mov_b64 v[152:153], 0
    v_mov_b64 v[154:155], 0
    v_mov_b64 v[156:157], 0
    v_mov_b64 v[158:159], 0
    s_branch L_C
L_retryH:
    s_add_u32 s60, s60, 1
    s_cmp_gt_u32 s60, 262144
    s_cbranch_scc1 L_exit
    buffer_load_dwordx4 v[32:35], v242, s[48:51], 0 offen sc1
    s_waitcnt vmcnt(0)
    s_branch L_H
L_retryVX:
    s_add_u32 s60, s60, 1
    s_cmp_gt_u32 s60, 262144
    s_cbranch_scc1 L_exit
    buffer_load_dwordx2 v[246:247], v244, s[48:51], 0 offen sc1
    s_waitcnt vmcnt(0)
    s_branch L_votesX
L_retryQ:
    s_add_u32 s60, s60, 1
    s_cmp_gt_u32 s60, 262144
    s_cbranch_scc1 L_exit
    s_waitcnt vmcnt(0) lgkmcnt(0)
    s_barrier
    s_add_u32 m0, s27, 104448
    s_nop 0
    buffer_load_dwordx4 v15, s[48:51], s36 offen offset:0 sc1 lds
    buffer_load_dwordx4 v15, s[48:51], s36 offen offset:1024 sc1 lds
    buffer_load_dwordx4 v15, s[48:51], s36 offen offset:2048 sc1 lds
    s_add_u32 m0, s27, 116736
    s_nop 0
    buffer_load_dwordx4 v15, s[48:51], s37 offen offset:0 sc1 lds
    buffer_load_dwordx4 v15, s[48:51], s37 offen offset:1024 sc1 lds
    buffer_load_dwordx4 v15, s[48:51], s37 offen offset:2048 sc1 lds
    s_add_u32 m0, s27, 129024
    s_nop 0
    buffer_load_dwordx4 v15, s[48:51], s38 offen offset:0 sc1 lds
    buffer_load_dwordx4 v15, s[48:51], s38 offen offset:1024 sc1 lds
    buffer_load_dwordx4 v15, s[48:51], s38 offen offset:2048 sc1 lds
    s_add_u32 m0, s27, 141312
    s_nop 0
    buffer_load_dwordx4 v15, s[48:51], s39 offen offset:0 sc1 lds
    buffer_load_dwordx4 v15, s[48:51], s39 offen offset:1024 sc1 lds
    buffer_load_dwordx4 v15, s[48:51], s39 offen offset:2048 sc1 lds
    s_waitcnt vmcnt(0)
    s_branch L_S
L_Y:
    s_mov_b32 s60, 0
    s_mov_b32 s61, 0x05040100
    s_mov_b32 s62, 0x07060302
    s_mov_b32 s48, s28
    s_and_b32 s49, s29, 0xffff
    s_mov_b32 s50, 0x840000
    s_mov_b32 s51, 0x20000
    s_load_dword s100, s[28:29], 0
    s_waitcnt vmcnt(12)
    s_xor_b32 s56, s3, 2
    s_lshl_b32 s56, s56, 20
    buffer_load_dwordx4 v[128:131], v14, s[36:39], s56 offen
    v_mov_b32 v10, 0x3f803f80
    v_mov_b32 v8, 0
    v_mov_b32 v9, 0
    v_and_b32 v11, 3, v1
    s_addk_i32 s56, 0x2000
    buffer_load_dwordx4 v[132:135], v14, s[36:39], s56 offen
    v_cmp_eq_u32 vcc, 1, v11
    v_dot2c_f32_bf16 v8, v16, v10
    v_dot2c_f32_bf16 v9, v16, v16
    v_dot2c_f32_bf16 v8, v17, v10
    s_addk_i32 s56, 0x2000
    buffer_load_dwordx4 v[136:139], v14, s[36:39], s56 offen
    v_dot2c_f32_bf16 v9, v17, v17
    v_dot2c_f32_bf16 v8, v18, v10
    v_dot2c_f32_bf16 v9, v18, v18
    v_dot2c_f32_bf16 v8, v19, v10
    s_addk_i32 s56, 0x2000
    buffer_load_dwordx4 v[140:143], v14, s[36:39], s56 offen
    v_dot2c_f32_bf16 v9, v19, v19
    v_dot2c_f32_bf16 v8, v20, v10
    v_dot2c_f32_bf16 v9, v20, v20
    v_dot2c_f32_bf16 v8, v21, v10
    s_addk_i32 s56, 0x2000
    buffer_load_dwordx4 v[144:147], v14, s[36:39], s56 offen
    v_dot2c_f32_bf16 v9, v21, v21
    v_dot2c_f32_bf16 v8, v22, v10
    v_dot2c_f32_bf16 v9, v22, v22
    v_dot2c_f32_bf16 v8, v23, v10
    s_addk_i32 s56, 0x2000
    buffer_load_dwordx4 v[148:151], v14, s[36:39], s56 offen
    v_dot2c_f32_bf16 v9, v23, v23
    v_dot2c_f32_bf16 v8, v24, v10
    v_dot2c_f32_bf16 v9, v24, v24
    v_dot2c_f32_bf16 v8, v25, v10
    s_addk_i32 s56, 0x2000
    buffer_load_dwordx4 v[152:155], v14, s[36:39], s56 offen
    v_dot2c_f32_bf16 v9, v25, v25
    v_dot2c_f32_bf16 v8, v26, v10
    v_dot2c_f32_bf16 v9, v26, v26
    v_dot2c_f32_bf16 v8, v27, v10
    s_addk_i32 s56, 0x2000
    buffer_load_dwordx4 v[156:159], v14, s[36:39], s56 offen
    v_dot2c_f32_bf16 v9, v27, v27
    v_dot2c_f32_bf16 v8, v28, v10
    v_dot2c_f32_bf16 v9, v28, v28
    v_dot2c_f32_bf16 v8, v29, v10
    v_dot2c_f32_bf16 v9, v29, v29
    v_dot2c_f32_bf16 v8, v30, v10
    v_dot2c_f32_bf16 v9, v30, v30
    v_dot2c_f32_bf16 v8, v31, v10
    v_dot2c_f32_bf16 v9, v31, v31
    v_cndmask_b32 v16, v16, v10, vcc
    v_cndmask_b32 v17, v17, v10, vcc
    v_cndmask_b32 v18, v18, v10, vcc
    v_cndmask_b32 v19, v19, v10, vcc
    v_cndmask_b32 v20, v20, v10, vcc
    v_cndmask_b32 v21, v21, v10, vcc
    v_cndmask_b32 v22, v22, v10, vcc
    v_cndmask_b32 v23, v23, v10, vcc
    v_cndmask_b32 v24, v24, v10, vcc
    v_cndmask_b32 v25, v25, v10, vcc
    v_cndmask_b32 v26, v26, v10, vcc
    v_cndmask_b32 v27, v27, v10, vcc
    v_cndmask_b32 v28, v28, v10, vcc
    v_cndmask_b32 v29, v29, v10, vcc
    v_cndmask_b32 v30, v30, v10, vcc
    v_cndmask_b32 v31, v31, v10, vcc
    v_add_f32_dpp v8, v8, v8 quad_perm:[1,0,3,2] row_mask:0xf bank_mask:0xf
    v_add_f32_dpp v9, v9, v9 quad_perm:[1,0,3,2] row_mask:0xf bank_mask:0xf
    s_nop 0
    v_add_f32_dpp v8, v8, v8 quad_perm:[2,3,0,1] row_mask:0xf bank_mask:0xf
    v_add_f32_dpp v9, v9, v9 quad_perm:[2,3,0,1] row_mask:0xf bank_mask:0xf
    v_mov_b32 v10, v8
    v_mov_b32 v11, v9
    s_nop 0
    v_permlane16_swap_b32 v10, v8
    v_permlane16_swap_b32 v11, v9
    v_add_f32 v8, v8, v10
    v_add_f32 v9, v9, v11
    v_mov_b32 v10, v8
    v_mov_b32 v11, v9
    s_nop 0
    v_permlane32_swap_b32 v10, v8
    v_permlane32_swap_b32 v11, v9
    v_add_f32 v8, v8, v10
    v_add_f32 v9, v9, v11
    v_mul_f32 v8, 0x3b000000, v8
    v_mul_f32 v9, 0x3b000000, v9
    v_fma_f32 v9, -v8, v8, v9
    v_max_f32 v9, 0, v9
    v_cvt_pk_bf16_f32 v9, v9, v8
    v_and_b32 v8, 0xffff0000, v9
    v_lshlrev_b32 v9, 16, v9
    v_add_f32 v9, 0x3727c5ac, v9
    v_cvt_pk_bf16_f32 v9, v9, v9
    v_lshlrev_b32 v9, 16, v9
    v_sqrt_f32 v9, v9
    v_xor_b32 v8, 0x80000000, v8
    v_cvt_pk_bf16_f32 v9, v9, v9
    v_lshlrev_b32 v9, 16, v9
    v_rcp_f32 v9, v9
    v_and_b32 v10, 0x30, v1
    ds_bpermute_b32 v12, v10, v8
    ds_bpermute_b32 v13, v10, v9
    s_waitcnt vmcnt(16)
    s_xor_b32 s56, s3, 3
    s_lshl_b32 s56, s56, 20
    buffer_load_dwordx4 v[160:163], v14, s[36:39], s56 offen
    v_perm_b32 v224, v68, v64, s61
    s_mov_b32 s40, s10
    v_perm_b32 v225, v76, v72, s61
    s_and_b32 s41, s11, 0xffff
    v_perm_b32 v226, v84, v80, s61
    s_mov_b32 s42, 0x400000
    s_mov_b32 s43, 0x20000
    v_perm_b32 v227, v92, v88, s61
    s_mov_b32 s44, s6
    v_perm_b32 v228, v68, v64, s62
    s_and_b32 s45, s7, 0xffff
    s_mov_b32 s46, 0x1000000
    s_addk_i32 s56, 0x2000
    buffer_load_dwordx4 v[164:167], v14, s[36:39], s56 offen
    v_perm_b32 v229, v76, v72, s62
    s_mov_b32 s47, 0x20000
    v_mfma_f32_16x16x32_bf16 v[32:35], v[16:19], v[224:227], 0
    s_lshl_b32 s34, s3, 2
    s_add_u32 s34, s34, s30
    v_perm_b32 v230, v84, v80, s62
    s_lshl_b32 s34, s34, 18
    v_perm_b32 v231, v92, v88, s62
    s_add_u32 s34, s34, s35
    v_lshl_add_u32 v7, v4, 13, s34
    v_perm_b32 v224, v69, v65, s61
    v_lshl_add_u32 v240, v6, 4, v7
    s_addk_i32 s56, 0x2000
    buffer_load_dwordx4 v[168:171], v14, s[36:39], s56 offen
    v_perm_b32 v225, v77, v73, s61
    v_xor_b32 v241, 64, v240
    v_mfma_f32_16x16x32_bf16 v[36:39], v[16:19], v[228:231], 0
    v_xor_b32 v242, 0x80, v240
    v_xor_b32 v243, 0xc0, v240
    v_perm_b32 v226, v85, v81, s61
    s_lshl_b32 s34, s30, 13
    v_perm_b32 v227, v93, v89, s61
    s_add_u32 s34, s34, 131072
    v_lshrrev_b32 v8, 2, v5
    v_perm_b32 v228, v69, v65, s62
    v_lshl_add_u32 v9, v8, 11, s34
    s_addk_i32 s56, 0x2000
    buffer_load_dwordx4 v[172:175], v14, s[36:39], s56 offen
    v_perm_b32 v229, v77, v73, s62
    v_and_b32 v10, 3, v5
    v_lshl_add_u32 v9, v10, 8, v9
    v_mfma_f32_16x16x32_bf16 v[40:43], v[16:19], v[224:227], 0
    v_lshl_add_u32 v244, v6, 4, v9
    v_perm_b32 v230, v85, v81, s62
    v_lshlrev_b32 v9, 10, v10
    v_lshl_add_u32 v9, v8, 8, v9
    v_perm_b32 v231, v93, v89, s62
    v_lshl_add_u32 v9, v6, 4, v9
    v_perm_b32 v224, v70, v66, s61
    v_add_u32 v245, 32768, v9
    s_addk_i32 s56, 0x2000
    buffer_load_dwordx4 v[176:179], v14, s[36:39], s56 offen
    v_xor_b32 v246, 64, v245
    v_perm_b32 v225, v78, v74, s61
    v_xor_b32 v247, 0x80, v245
    v_mfma_f32_16x16x32_bf16 v[44:47], v[16:19], v[228:231], 0
    v_xor_b32 v254, 0xc0, v245
    v_perm_b32 v226, v86, v82, s61
    v_lshl_add_u32 v9, v4, 2, s30
    v_xor_b32 v9, v9, v5
    v_perm_b32 v227, v94, v90, s61
    v_lshlrev_b32 v9, 4, v9
    v_perm_b32 v228, v70, v66, s62
    v_lshl_add_u32 v9, v4, 8, v9
    s_addk_i32 s56, 0x2000
    buffer_load_dwordx4 v[180:183], v14, s[36:39], s56 offen
    s_lshl_b32 s34, s30, 10
    v_perm_b32 v229, v78, v74, s62
    s_add_u32 s34, s34, 32768
    v_mfma_f32_16x16x32_bf16 v[48:51], v[16:19], v[224:227], 0
    v_add_u32 v248, s34, v9
    s_bfe_u32 s35, s63, 0x30001
    v_perm_b32 v230, v86, v82, s62
    s_mul_i32 s34, s30, 3
    v_perm_b32 v231, v94, v90, s62
    v_mul_u32_u24 v15, 384, v8
    v_add_u32 v15, 36864, v15
    v_perm_b32 v224, v71, v67, s61
    s_addk_i32 s56, 0x2000
    buffer_load_dwordx4 v[184:187], v14, s[36:39], s56 offen
    v_lshrrev_b32 v8, 1, v4
    v_perm_b32 v225, v79, v75, s61
    v_and_b32 v9, 1, v4
    v_mfma_f32_16x16x32_bf16 v[52:55], v[16:19], v[228:231], 0
    v_add_u32 v10, s34, v9
    v_lshlrev_b32 v11, 2, v8
    v_perm_b32 v226, v87, v83, s61
    v_add3_u32 v11, v11, v10, 8
    v_perm_b32 v227, v95, v91, s61
    v_cmp_lt_u32 vcc, 7, v10
    v_lshl_add_u32 v249, v8, 3, v10
    v_perm_b32 v228, v71, v67, s62
    s_addk_i32 s56, 0x2000
    buffer_load_dwordx4 v[188:191], v14, s[36:39], s56 offen
    v_cndmask_b32 v249, v249, v11, vcc
    v_perm_b32 v229, v79, v75, s62
    v_xor_b32 v249, s35, v249
    v_lshlrev_b32 v249, 4, v249
    v_mfma_f32_16x16x32_bf16 v[56:59], v[16:19], v[224:227], 0
    v_add_u32 v10, 1, v10
    v_perm_b32 v230, v87, v83, s62
    v_lshlrev_b32 v11, 2, v8
    v_add3_u32 v11, v11, v10, 8
    v_perm_b32 v231, v95, v91, s62
    v_cmp_lt_u32 vcc, 7, v10
    s_nop 0
    v_mfma_f32_16x16x32_bf16 v[60:63], v[16:19], v[228:231], 0
    v_lshl_add_u32 v250, v8, 3, v10
    v_cndmask_b32 v250, v250, v11, vcc
    s_lshl_b32 s17, s30, 13
    s_waitcnt vmcnt(16)
    s_add_u32 m0, s17, 131072
    s_mov_b32 s56, 0
    buffer_load_dwordx4 v240, s[40:43], s56 offen nt lds
    v_perm_b32 v224, v100, v96, s61
    v_xor_b32 v250, s35, v250
    v_perm_b32 v225, v108, v104, s61
    v_lshlrev_b32 v250, 4, v250
    v_perm_b32 v226, v116, v112, s61
    v_add_u32 v249, v15, v249
    v_add_u32 v250, v15, v250
    v_perm_b32 v227, v124, v120, s61
    v_cmp_eq_u32 vcc, 1, v9
    v_perm_b32 v228, v100, v96, s62
    v_lshl_add_u32 v236, v9, 2, v249
    v_cndmask_b32 v237, v249, v250, vcc
    s_addk_i32 m0, 0x400
    s_add_u32 s56, s56, 0x8000
    buffer_load_dwordx4 v240, s[40:43], s56 offen nt lds
    v_perm_b32 v229, v108, v104, s62
    s_mul_i32 s34, s30, 384
    v_mfma_f32_16x16x32_bf16 v[32:35], v[20:23], v[224:227], v[32:35]
    s_add_u32 s34, s34, 36864
    v_lshl_add_u32 v251, v1, 4, s34
    v_perm_b32 v230, v116, v112, s62
    s_mul_i32 s34, s30, 49152
    v_perm_b32 v231, v124, v120, s62
    s_mul_i32 s35, s3, 12288
    s_add_u32 s34, s34, s35
    v_perm_b32 v224, v101, v97, s61
    s_mul_i32 s35, s63, 384
    s_addk_i32 m0, 0x400
    s_add_u32 s56, s56, 0x8000
    buffer_load_dwordx4 v241, s[40:43], s56 offen nt lds
    v_perm_b32 v225, v109, v105, s61
    s_add_u32 s34, s34, s35
    v_mfma_f32_16x16x32_bf16 v[36:39], v[20:23], v[228:231], v[36:39]
    s_add_u32 s34, s34, 4096
    v_lshl_add_u32 v252, v1, 4, s34
    v_perm_b32 v226, v117, v113, s61
    s_lshl_b32 s34, s63, 19
    v_perm_b32 v227, v125, v121, s61
    s_lshl_b32 s35, s3, 8
    s_add_u32 s34, s34, s35
    v_perm_b32 v228, v101, v97, s62
    s_lshl_b32 s35, s30, 15
    s_addk_i32 m0, 0x400
    s_add_u32 s56, s56, 0x8000
    buffer_load_dwordx4 v241, s[40:43], s56 offen nt lds
    v_perm_b32 v229, v109, v105, s62
    s_add_u32 s34, s34, s35
    v_lshlrev_b32 v8, 2, v4
    v_mfma_f32_16x16x32_bf16 v[40:43], v[20:23], v[224:227], v[40:43]
    v_xor_b32 v8, v8, v5
    v_perm_b32 v230, v117, v113, s62
    v_lshl_add_u32 v8, v8, 4, s34
    v_lshl_add_u32 v253, v4, 10, v8
    v_perm_b32 v231, v125, v121, s62
    s_lshl_b32 s34, s63, 2
    v_perm_b32 v224, v102, v98, s61
    s_add_u32 s34, s34, s3
    s_addk_i32 m0, 0x400
    s_add_u32 s56, s56, 0x8000
    buffer_load_dwordx4 v242, s[40:43], s56 offen nt lds
    s_lshr_b32 s35, s34, 3
    v_perm_b32 v225, v110, v106, s61
    s_lshl_b32 s35, s35, 4
    v_mfma_f32_16x16x32_bf16 v[44:47], v[20:23], v[228:231], v[44:47]
    s_and_b32 s34, s34, 7
    v_perm_b32 v226, v118, v114, s61
    s_add_u32 s34, s34, s35
    s_lshl_b32 s34, s34, 2
    v_perm_b32 v227, v126, v122, s61
    s_lshl_b32 s35, s30, 13
    v_perm_b32 v228, v102, v98, s62
    s_add_u32 s34, s34, s35
    s_addk_i32 m0, 0x400
    s_add_u32 s56, s56, 0x8000
    buffer_load_dwordx4 v242, s[40:43], s56 offen nt lds
    s_add_u32 s34, s34, 262144
    v_perm_b32 v229, v110, v106, s62
    v_lshl_add_u32 v233, v1, 10, s34
    v_mfma_f32_16x16x32_bf16 v[48:51], v[20:23], v[224:227], v[48:51]
    s_lshl_b32 s35, s3, 4
    s_add_u32 s35, s35, s30
    v_perm_b32 v230, v118, v114, s62
    v_lshl_add_u32 v6, v4, 2, s35
    v_perm_b32 v231, v126, v122, s62
    v_mul_u32_u24 v6, 28672, v6
    v_and_b32 v7, 7, v1
    v_perm_b32 v224, v103, v99, s61
    s_addk_i32 m0, 0x400
    s_add_u32 s56, s56, 0x8000
    buffer_load_dwordx4 v243, s[40:43], s56 offen nt lds
    v_lshl_add_u32 v6, v7, 4, v6
    v_perm_b32 v225, v111, v107, s61
    s_lshl_b32 s34, s63, 7
    v_mfma_f32_16x16x32_bf16 v[52:55], v[20:23], v[228:231], v[52:55]
    v_add_u32 v6, s34, v6
    s_cmp_lt_u32 s63, 28
    s_cselect_b32 s34, -1, 0
    v_perm_b32 v226, v119, v115, s61
    v_and_b32 v6, s34, v6
    v_perm_b32 v227, v127, v123, s61
    v_mov_b32 v7, 0
    v_cmp_gt_u32 vcc, 8, v5
    v_perm_b32 v228, v103, v99, s62
    s_addk_i32 m0, 0x400
    s_add_u32 s56, s56, 0x8000
    buffer_load_dwordx4 v243, s[40:43], s56 offen nt lds
    v_mov_b32 v234, s20
    v_perm_b32 v229, v111, v107, s62
    v_mov_b32 v235, s21
    v_mov_b32 v10, s18
    v_mfma_f32_16x16x32_bf16 v[56:59], v[20:23], v[224:227], v[56:59]
    v_mov_b32 v11, s19
    v_perm_b32 v230, v119, v115, s62
    v_cndmask_b32 v234, v234, v10, vcc
    v_cndmask_b32 v235, v235, v11, vcc
    v_perm_b32 v231, v127, v123, s62
    v_lshl_add_u64 v[234:235], v[6:7], 0, v[234:235]
    s_nop 0
    v_mfma_f32_16x16x32_bf16 v[60:63], v[20:23], v[228:231], v[60:63]
    s_mov_b32 s26, 7168
    s_mov_b32 s27, 0
    s_waitcnt lgkmcnt(0)
    s_mul_i32 s100, s100, 0x9e3779b1
    s_add_u32 s100, s100, 0x7f4a7c15
    s_mov_b32 s101, s100
    s_mul_i32 s99, s100, 3
    v_mov_b32 v232, s100
    v_mov_b32 v239, s100
    ds_write_b32 v237, v239 offset:12
    ds_write_b32 v236, v239
    v_xor_b32 v241, 64, v244
    v_xor_b32 v242, 0x80, v244
    v_xor_b32 v243, 0xc0, v244
    v_mul_f32 v15, 0x3e0293ee, v13
    s_waitcnt vmcnt(16)
    v_perm_b32 v224, v132, v128, s61
    v_perm_b32 v225, v140, v136, s61
    v_perm_b32 v226, v148, v144, s61
    v_perm_b32 v227, v156, v152, s61
    v_perm_b32 v228, v132, v128, s62
    v_perm_b32 v229, v140, v136, s62
    v_mfma_f32_16x16x32_bf16 v[32:35], v[24:27], v[224:227], v[32:35]
    v_perm_b32 v230, v148, v144, s62
    v_perm_b32 v231, v156, v152, s62
    v_perm_b32 v224, v133, v129, s61
    v_perm_b32 v225, v141, v137, s61
    v_mfma_f32_16x16x32_bf16 v[36:39], v[24:27], v[228:231], v[36:39]
    v_perm_b32 v226, v149, v145, s61
    v_perm_b32 v227, v157, v153, s61
    v_perm_b32 v228, v133, v129, s62
    v_perm_b32 v229, v141, v137, s62
    v_mfma_f32_16x16x32_bf16 v[40:43], v[24:27], v[224:227], v[40:43]
    v_perm_b32 v230, v149, v145, s62
    v_perm_b32 v231, v157, v153, s62
    v_perm_b32 v224, v134, v130, s61
    v_perm_b32 v225, v142, v138, s61
    v_mfma_f32_16x16x32_bf16 v[44:47], v[24:27], v[228:231], v[44:47]
    v_perm_b32 v226, v150, v146, s61
    v_perm_b32 v227, v158, v154, s61
    v_perm_b32 v228, v134, v130, s62
    v_perm_b32 v229, v142, v138, s62
    v_mfma_f32_16x16x32_bf16 v[48:51], v[24:27], v[224:227], v[48:51]
    v_perm_b32 v230, v150, v146, s62
    v_perm_b32 v231, v158, v154, s62
    v_perm_b32 v224, v135, v131, s61
    v_perm_b32 v225, v143, v139, s61
    v_mfma_f32_16x16x32_bf16 v[52:55], v[24:27], v[228:231], v[52:55]
    v_perm_b32 v226, v151, v147, s61
    v_perm_b32 v227, v159, v155, s61
    v_perm_b32 v228, v135, v131, s62
    v_perm_b32 v229, v143, v139, s62
    v_mfma_f32_16x16x32_bf16 v[56:59], v[24:27], v[224:227], v[56:59]
    v_perm_b32 v230, v151, v147, s62
    v_perm_b32 v231, v159, v155, s62
    s_nop 1
    v_mfma_f32_16x16x32_bf16 v[60:63], v[24:27], v[228:231], v[60:63]
    s_waitcnt vmcnt(8)
    v_perm_b32 v224, v164, v160, s61
    v_perm_b32 v225, v172, v168, s61
    v_perm_b32 v226, v180, v176, s61
    v_perm_b32 v227, v188, v184, s61
    v_perm_b32 v228, v164, v160, s62
    v_perm_b32 v229, v172, v168, s62
    v_mfma_f32_16x16x32_bf16 v[32:35], v[28:31], v[224:227], v[32:35]
    v_perm_b32 v230, v180, v176, s62
    v_perm_b32 v231, v188, v184, s62
    v_perm_b32 v224, v165, v161, s61
    v_perm_b32 v225, v173, v169, s61
    v_mfma_f32_16x16x32_bf16 v[36:39], v[28:31], v[228:231], v[36:39]
    v_perm_b32 v226, v181, v177, s61
    v_perm_b32 v227, v189, v185, s61
    v_perm_b32 v228, v165, v161, s62
    v_perm_b32 v229, v173, v169, s62
    v_mfma_f32_16x16x32_bf16 v[40:43], v[28:31], v[224:227], v[40:43]
    v_perm_b32 v230, v181, v177, s62
    v_perm_b32 v231, v189, v185, s62
    v_perm_b32 v224, v166, v162, s61
    v_perm_b32 v225, v174, v170, s61
    v_mfma_f32_16x16x32_bf16 v[44:47], v[28:31], v[228:231], v[44:47]
    v_perm_b32 v226, v182, v178, s61
    v_perm_b32 v227, v190, v186, s61
    v_perm_b32 v228, v166, v162, s62
    v_perm_b32 v229, v174, v170, s62
    v_mfma_f32_16x16x32_bf16 v[48:51], v[28:31], v[224:227], v[48:51]
    v_perm_b32 v230, v182, v178, s62
    v_perm_b32 v231, v190, v186, s62
    v_perm_b32 v224, v167, v163, s61
    v_perm_b32 v225, v175, v171, s61
    v_mfma_f32_16x16x32_bf16 v[52:55], v[28:31], v[228:231], v[52:55]
    v_perm_b32 v226, v183, v179, s61
    v_perm_b32 v227, v191, v187, s61
    v_perm_b32 v228, v167, v163, s62
    v_perm_b32 v229, v175, v171, s62
    v_mfma_f32_16x16x32_bf16 v[56:59], v[28:31], v[224:227], v[56:59]
    v_perm_b32 v230, v183, v179, s62
    v_perm_b32 v231, v191, v187, s62
    s_nop 1
    v_mfma_f32_16x16x32_bf16 v[60:63], v[28:31], v[228:231], v[60:63]
    v_fma_f32 v224, v12, v33, v32
    v_fma_f32 v225, v12, v37, v36
    v_fma_f32 v226, v12, v41, v40
    v_fma_f32 v227, v12, v45, v44
    v_fma_f32 v228, v12, v49, v48
    v_fma_f32 v229, v12, v53, v52
    v_fma_f32 v230, v12, v57, v56
    s_nop 0
    v_fma_f32 v231, v12, v61, v60
    v_mul_f32 v224, v15, v224
    v_mul_f32 v225, v15, v225
    v_mul_f32 v226, v15, v226
    v_mul_f32 v227, v15, v227
    v_mul_f32 v228, v15, v228
    v_mul_f32 v229, v15, v229
    v_mul_f32 v230, v15, v230
    v_mul_f32 v231, v15, v231
    v_cvt_pk_bf16_f32 v224, v224, v225
    v_cvt_pk_bf16_f32 v225, v226, v227
    v_cvt_pk_bf16_f32 v226, v228, v229
    v_cvt_pk_bf16_f32 v227, v230, v231
    ds_write_b128 v248, v[224:227]
    s_waitcnt vmcnt(0)
    ds_read_b128 v[192:195], v244 offset:0
    ds_read_b128 v[208:211], v244 offset:1024
    ds_read_b128 v[196:199], v241 offset:0
    ds_read_b128 v[212:215], v241 offset:1024
    ds_read_b128 v[200:203], v242 offset:0
    ds_read_b128 v[216:219], v242 offset:1024
    ds_read_b128 v[204:207], v243 offset:0
    ds_read_b128 v[220:223], v243 offset:1024
    s_waitcnt lgkmcnt(8)
    s_barrier
    ds_read_b32 v238, v238
    ds_read_b128 v[64:67], v245
    ds_read_b128 v[68:71], v246
    ds_read_b128 v[72:75], v247
    ds_read_b128 v[76:79], v254
    s_waitcnt lgkmcnt(4)
    v_xor_b32 v232, s100, v238
    s_waitcnt lgkmcnt(3)
    v_mfma_f32_16x16x32_bf16 v[32:35], v[192:195], v[64:67], 0
    v_mfma_f32_16x16x32_bf16 v[36:39], v[208:211], v[64:67], 0
    s_waitcnt lgkmcnt(2)
    v_mfma_f32_16x16x32_bf16 v[32:35], v[196:199], v[68:71], v[32:35]
    v_mfma_f32_16x16x32_bf16 v[36:39], v[212:215], v[68:71], v[36:39]
    s_waitcnt lgkmcnt(1)
    v_mfma_f32_16x16x32_bf16 v[32:35], v[200:203], v[72:75], v[32:35]
    v_mfma_f32_16x16x32_bf16 v[36:39], v[216:219], v[72:75], v[36:39]
    s_waitcnt lgkmcnt(0)
    v_mfma_f32_16x16x32_bf16 v[32:35], v[204:207], v[76:79], v[32:35]
    v_mfma_f32_16x16x32_bf16 v[36:39], v[220:223], v[76:79], v[36:39]
    s_mov_b64 exec, 255
    buffer_store_dword v232, v233, s[48:51], 0 offen sc1
    s_mov_b64 exec, -1
    v_cmp_gt_u32 vcc, 24, v1
    s_nop 2
    v_add_f32_dpp v32, v32, v32 quad_perm:[1,0,3,2] row_mask:0xf bank_mask:0xf
    v_add_f32_dpp v33, v33, v33 quad_perm:[1,0,3,2] row_mask:0xf bank_mask:0xf
    v_add_f32_dpp v34, v34, v34 quad_perm:[1,0,3,2] row_mask:0xf bank_mask:0xf
    v_add_f32_dpp v35, v35, v35 quad_perm:[1,0,3,2] row_mask:0xf bank_mask:0xf
    v_add_f32_dpp v36, v36, v36 quad_perm:[1,0,3,2] row_mask:0xf bank_mask:0xf
    v_add_f32_dpp v37, v37, v37 quad_perm:[1,0,3,2] row_mask:0xf bank_mask:0xf
    v_add_f32_dpp v38, v38, v38 quad_perm:[1,0,3,2] row_mask:0xf bank_mask:0xf
    v_add_f32_dpp v39, v39, v39 quad_perm:[1,0,3,2] row_mask:0xf bank_mask:0xf
    v_add_f32_dpp v32, v32, v32 quad_perm:[2,3,0,1] row_mask:0xf bank_mask:0xf
    v_add_f32_dpp v33, v33, v33 quad_perm:[2,3,0,1] row_mask:0xf bank_mask:0xf
    v_add_f32_dpp v34, v34, v34 quad_perm:[2,3,0,1] row_mask:0xf bank_mask:0xf
    v_add_f32_dpp v35, v35, v35 quad_perm:[2,3,0,1] row_mask:0xf bank_mask:0xf
    v_add_f32_dpp v36, v36, v36 quad_perm:[2,3,0,1] row_mask:0xf bank_mask:0xf
    v_add_f32_dpp v37, v37, v37 quad_perm:[2,3,0,1] row_mask:0xf bank_mask:0xf
    v_add_f32_dpp v38, v38, v38 quad_perm:[2,3,0,1] row_mask:0xf bank_mask:0xf
    v_add_f32_dpp v39, v39, v39 quad_perm:[2,3,0,1] row_mask:0xf bank_mask:0xf
    v_cvt_pk_bf16_f32 v224, v32, v33
    v_cvt_pk_bf16_f32 v225, v34, v35
    v_cvt_pk_bf16_f32 v226, v36, v37
    v_cvt_pk_bf16_f32 v227, v38, v39
    ds_write_b64 v249, v[224:225] offset:8
    ds_write_b32 v250, v226
    ds_write_b32 v237, v227 offset:4
    s_waitcnt lgkmcnt(0)
    s_barrier
    ds_read_b128 v[40:43], v251
    s_mov_b64 exec, vcc
    s_waitcnt lgkmcnt(0)
    buffer_store_dwordx4 v[40:43], v252, s[48:51], 0 offen sc1
    s_mov_b64 exec, -1
    s_barrier
    v_mov_b32 v232, s100
    s_add_u32 m0, s17, 98304
    s_add_u32 s56, s3, 4
    s_and_b32 s56, s56, 3
    s_lshl_b32 s56, s56, 17
    buffer_load_dwordx4 v253, s[44:47], s56 offen lds
    s_addk_i32 m0, 0x400
    s_addk_i32 s56, 0x1000
    buffer_load_dwordx4 v253, s[44:47], s56 offen lds
    s_addk_i32 m0, 0x400
    s_addk_i32 s56, 0x1000
    buffer_load_dwordx4 v253, s[44:47], s56 offen lds
    s_addk_i32 m0, 0x400
    s_addk_i32 s56, 0x1000
    buffer_load_dwordx4 v253, s[44:47], s56 offen lds
    s_addk_i32 m0, 0x400
    s_addk_i32 s56, 0x1000
    buffer_load_dwordx4 v253, s[44:47], s56 offen lds
    s_addk_i32 m0, 0x400
    s_addk_i32 s56, 0x1000
    buffer_load_dwordx4 v253, s[44:47], s56 offen lds
    s_addk_i32 m0, 0x400
    s_addk_i32 s56, 0x1000
    buffer_load_dwordx4 v253, s[44:47], s56 offen lds
    s_addk_i32 m0, 0x400
    s_addk_i32 s56, 0x1000
    buffer_load_dwordx4 v253, s[44:47], s56 offen lds
    s_add_u32 m0, s17, 65536
    s_add_u32 s56, s3, 3
    s_and_b32 s56, s56, 3
    s_lshl_b32 s56, s56, 17
    buffer_load_dwordx4 v253, s[44:47], s56 offen lds
    s_addk_i32 m0, 0x400
    s_addk_i32 s56, 0x1000
    buffer_load_dwordx4 v253, s[44:47], s56 offen lds
    s_addk_i32 m0, 0x400
    s_addk_i32 s56, 0x1000
    buffer_load_dwordx4 v253, s[44:47], s56 offen lds
    v_lshrrev_b32 v8, 5, v1
    v_bfe_u32 v9, v1, 2, 2
    v_lshlrev_b32 v10, 10, v8
    v_lshl_add_u32 v10, v9, 8, v10
    v_xor_b32 v9, s30, v9
    v_lshl_add_u32 v10, v9, 6, v10
    v_bfe_u32 v9, v1, 4, 1
    v_lshl_add_u32 v10, v9, 5, v10
    v_and_b32 v9, 3, v1
    v_lshl_add_u32 v160, v9, 3, v10
    v_add_u32 v161, 0x10000, v160
    s_and_b32 s34, s63, 15
    s_lshl_b32 s34, s34, 5
    s_and_b32 s35, s30, 2
    s_add_u32 s35, s35, s30
    s_add_u32 s34, s34, s35
    s_lshr_b32 s35, s31, 2
    s_lshl_b32 s35, s35, 1
    s_add_u32 s34, s34, s35
    s_lshl_b32 s34, s34, 12
    s_xor_b32 s35, s34, 2097152
    s_mul_i32 s16, s30, 3072
    v_lshl_add_u32 v162, v1, 4, s35
    v_lshlrev_b32 v163, 4, v1
    v_add_u32 v163, 65536, v163
    v_and_b32 v9, 31, v1
    s_add_u32 s36, s3, 1
    s_and_b32 s36, s36, 3
    s_lshl_b32 s36, s36, 15
    s_add_u32 s37, s3, 2
    s_and_b32 s37, s37, 3
    s_lshl_b32 s37, s37, 15
    s_add_u32 s38, s3, 3
    s_and_b32 s38, s38, 3
    s_lshl_b32 s38, s38, 15
    s_add_u32 s39, s3, 4
    s_and_b32 s39, s39, 3
    s_lshl_b32 s39, s39, 15
    s_lshr_b32 s34, s3, 1
    s_lshl_b32 s34, s34, 5
    s_add_u32 s34, s34, s63
    s_lshl_b32 s34, s34, 1
    s_and_b32 s35, s3, 1
    s_add_u32 s34, s34, s35
    s_lshr_b32 s35, s34, 3
    s_lshl_b32 s35, s35, 4
    s_and_b32 s34, s34, 7
    s_add_u32 s34, s34, s35
    s_lshl_b32 s34, s34, 2
    s_lshl_b32 s35, s30, 12
    s_add_u32 s34, s34, s35
    s_add_u32 s34, s34, 458752
    v_lshl_add_u32 v233, v1, 10, s34
    s_lshl_b32 s57, s63, 2
    s_add_u32 s57, s57, s3
    s_lshl_b32 s57, s57, 2
    s_add_u32 s57, s57, s30
    s_lshl_b32 s34, s57, 10
    s_add_u32 s34, s34, 851968
    v_lshl_add_u32 v30, v1, 4, s34
    s_and_b32 s57, s57, 15
    s_and_b32 s34, s63, 15
    s_and_b32 s35, s63, 8
    s_add_u32 s34, s34, s35
    s_lshr_b32 s35, s63, 4
    s_lshl_b32 s35, s35, 3
    s_add_u32 s34, s34, s35
    s_lshl_b32 s34, s34, 4
    s_add_u32 s57, s57, s34
    s_lshl_b32 s33, s57, 6
    s_and_b32 s34, s63, 31
    s_lshl_b32 s34, s34, 10
    s_add_u32 s34, s34, 262144
    v_lshrrev_b32 v20, 2, v1
    v_lshl_add_u32 v20, v20, 6, s34
    v_and_b32 v21, 3, v1
    v_lshl_add_u32 v20, v21, 3, v20
    v_mul_u32_u24 v9, 400, v9
    s_lshr_b32 s34, s30, 1
    s_mul_i32 s34, s34, 192
    s_add_u32 s34, s34, 131072
    v_add_u32 v9, s34, v9
    s_and_b32 s34, s30, 1
    s_mul_i32 s34, s34, 3
    v_mad_u32_u24 v10, v8, 6, s34
    s_bfe_u32 s35, s63, 0x20002
    v_add_u32 v11, 0, v10
    v_xor_b32 v11, s35, v11
    v_lshl_add_u32 v164, v11, 4, v9
    v_add_u32 v11, 1, v10
    v_xor_b32 v11, s35, v11
    v_lshl_add_u32 v165, v11, 4, v9
    v_add_u32 v11, 2, v10
    v_xor_b32 v11, s35, v11
    v_lshl_add_u32 v166, v11, 4, v9
    s_lshl_b32 s35, s3, 15
    s_mul_i32 s57, s63, 192
    s_add_u32 s35, s35, s57
    s_add_u32 s35, s35, 4194304
    s_mul_i32 s34, s30, 192
    v_add_u32 v9, s34, v1
    v_add_u32 v9, 0, v9
    v_mul_u32_u24 v10, 5462, v9
    v_lshrrev_b32 v10, 16, v10
    v_mul_u32_u24 v11, 12, v10
    v_sub_u32 v11, v9, v11
    v_lshrrev_b32 v7, 1, v10
    v_add_u32 v9, v9, v7
    v_lshlrev_b32 v9, 4, v9
    v_add_u32 v167, 131072, v9
    v_lshrrev_b32 v9, 4, v7
    v_and_b32 v7, 15, v7
    v_lshlrev_b32 v7, 17, v7
    v_lshl_add_u32 v7, v9, 13, v7
    v_and_b32 v10, 1, v10
    v_lshlrev_b32 v10, 14, v10
    v_lshl_add_u32 v10, v11, 4, v10
    v_add3_u32 v170, v7, v10, s35
    v_add_u32 v9, s34, v1
    v_add_u32 v9, 64, v9
    v_mul_u32_u24 v10, 5462, v9
    v_lshrrev_b32 v10, 16, v10
    v_mul_u32_u24 v11, 12, v10
    v_sub_u32 v11, v9, v11
    v_lshrrev_b32 v7, 1, v10
    v_add_u32 v9, v9, v7
    v_lshlrev_b32 v9, 4, v9
    v_add_u32 v168, 131072, v9
    v_lshrrev_b32 v9, 4, v7
    v_and_b32 v7, 15, v7
    v_lshlrev_b32 v7, 17, v7
    v_lshl_add_u32 v7, v9, 13, v7
    v_and_b32 v10, 1, v10
    v_lshlrev_b32 v10, 14, v10
    v_lshl_add_u32 v10, v11, 4, v10
    v_add3_u32 v171, v7, v10, s35
    v_add_u32 v9, s34, v1
    v_add_u32 v9, 128, v9
    v_mul_u32_u24 v10, 5462, v9
    v_lshrrev_b32 v10, 16, v10
    v_mul_u32_u24 v11, 12, v10
    v_sub_u32 v11, v9, v11
    v_lshrrev_b32 v7, 1, v10
    v_add_u32 v9, v9, v7
    v_lshlrev_b32 v9, 4, v9
    v_add_u32 v169, 131072, v9
    v_lshrrev_b32 v9, 4, v7
    v_and_b32 v7, 15, v7
    v_lshlrev_b32 v7, 17, v7
    v_lshl_add_u32 v7, v9, 13, v7
    v_and_b32 v10, 1, v10
    v_lshlrev_b32 v10, 14, v10
    v_lshl_add_u32 v10, v11, 4, v10
    v_add3_u32 v172, v7, v10, s35
    v_mov_b32 v176, s100
    v_mov_b32 v181, s100
    v_mov_b32 v187, s100
    s_cmp_lt_u32 s63, 28
    s_cselect_b32 s34, 0, 16777216
    v_add_u32 v30, s34, v30
    s_lshl_b32 s34, s30, 11
    s_add_u32 s34, s34, 151552
    v_lshl_add_u32 v28, v1, 4, s34
    s_lshr_b32 s34, s30, 1
    s_lshl_b32 s34, s34, 10
    s_and_b32 s35, s30, 1
    s_lshl_b32 s35, s35, 3
    s_add_u32 s34, s34, s35
    s_add_u32 s34, s34, 151552
    v_lshrrev_b32 v9, 1, v5
    v_lshlrev_b32 v9, 3, v9
    v_lshl_add_u32 v9, v4, 1, v9
    v_and_b32 v10, 1, v5
    v_add_u32 v9, v9, v10
    v_lshl_add_u32 v29, v9, 4, s34
    s_addk_i32 m0, 0x400
    s_addk_i32 s56, 0x1000
    buffer_load_dwordx4 v253, s[44:47], s56 offen lds
    s_addk_i32 m0, 0x400
    s_addk_i32 s56, 0x1000
    buffer_load_dwordx4 v253, s[44:47], s56 offen lds
    s_addk_i32 m0, 0x400
    s_addk_i32 s56, 0x1000
    buffer_load_dwordx4 v253, s[44:47], s56 offen lds
    s_addk_i32 m0, 0x400
    s_addk_i32 s56, 0x1000
    buffer_load_dwordx4 v253, s[44:47], s56 offen lds
    s_addk_i32 m0, 0x400
    s_addk_i32 s56, 0x1000
    buffer_load_dwordx4 v253, s[44:47], s56 offen lds
    s_add_u32 m0, s17, 0
    s_add_u32 s56, s3, 1
    s_and_b32 s56, s56, 3
    s_lshl_b32 s56, s56, 17
    buffer_load_dwordx4 v253, s[44:47], s56 offen lds
    s_addk_i32 m0, 0x400
    s_addk_i32 s56, 0x1000
    buffer_load_dwordx4 v253, s[44:47], s56 offen lds
    s_addk_i32 m0, 0x400
    s_addk_i32 s56, 0x1000
    buffer_load_dwordx4 v253, s[44:47], s56 offen lds
    s_addk_i32 m0, 0x400
    s_addk_i32 s56, 0x1000
    buffer_load_dwordx4 v253, s[44:47], s56 offen lds
    s_addk_i32 m0, 0x400
    s_addk_i32 s56, 0x1000
    buffer_load_dwordx4 v253, s[44:47], s56 offen lds
    s_addk_i32 m0, 0x400
    s_addk_i32 s56, 0x1000
    buffer_load_dwordx4 v253, s[44:47], s56 offen lds
    s_addk_i32 m0, 0x400
    s_addk_i32 s56, 0x1000
    buffer_load_dwordx4 v253, s[44:47], s56 offen lds
    s_addk_i32 m0, 0x400
    s_addk_i32 s56, 0x1000
    buffer_load_dwordx4 v253, s[44:47], s56 offen lds
    s_add_u32 m0, s17, 32768
    s_add_u32 s56, s3, 2
    s_and_b32 s56, s56, 3
    s_lshl_b32 s56, s56, 17
    buffer_load_dwordx4 v253, s[44:47], s56 offen lds
    s_addk_i32 m0, 0x400
    s_addk_i32 s56, 0x1000
    buffer_load_dwordx4 v253, s[44:47], s56 offen lds
    s_addk_i32 m0, 0x400
    s_addk_i32 s56, 0x1000
    buffer_load_dwordx4 v253, s[44:47], s56 offen lds
    s_addk_i32 m0, 0x400
    s_addk_i32 s56, 0x1000
    buffer_load_dwordx4 v253, s[44:47], s56 offen lds
    s_addk_i32 m0, 0x400
    s_addk_i32 s56, 0x1000
    buffer_load_dwordx4 v253, s[44:47], s56 offen lds
    s_addk_i32 m0, 0x400
    s_addk_i32 s56, 0x1000
    buffer_load_dwordx4 v253, s[44:47], s56 offen lds
    s_addk_i32 m0, 0x400
    s_addk_i32 s56, 0x1000
    buffer_load_dwordx4 v253, s[44:47], s56 offen lds
    s_addk_i32 m0, 0x400
    s_addk_i32 s56, 0x1000
    buffer_load_dwordx4 v253, s[44:47], s56 offen lds
    buffer_load_dwordx2 v[22:23], v20, s[48:51], 0 offen sc1
    s_waitcnt vmcnt(17)
    s_barrier
    ds_read_b64_tr_b16 a[96:97], v161 offset:32768
    ds_read_b64_tr_b16 a[98:99], v161 offset:34816
    ds_read_b64_tr_b16 a[100:101], v161 offset:36864
    ds_read_b64_tr_b16 a[102:103], v161 offset:38912
    ds_read_b64_tr_b16 a[104:105], v161 offset:40960
    ds_read_b64_tr_b16 a[106:107], v161 offset:43008
    ds_read_b64_tr_b16 a[108:109], v161 offset:45056
    ds_read_b64_tr_b16 a[110:111], v161 offset:47104
    ds_read_b64_tr_b16 a[112:113], v161 offset:49152
    ds_read_b64_tr_b16 a[114:115], v161 offset:51200
    ds_read_b64_tr_b16 a[116:117], v161 offset:53248
    ds_read_b64_tr_b16 a[118:119], v161 offset:55296
    ds_read_b64_tr_b16 a[120:121], v161 offset:57344
    ds_read_b64_tr_b16 a[122:123], v161 offset:59392
    ds_read_b64_tr_b16 a[124:125], v161 offset:61440
    ds_read_b64_tr_b16 a[126:127], v161 offset:63488
    ds_read_b64_tr_b16 a[64:65], v161 offset:0
    ds_read_b64_tr_b16 a[66:67], v161 offset:2048
    ds_read_b64_tr_b16 a[68:69], v161 offset:4096
    ds_read_b64_tr_b16 a[70:71], v161 offset:6144
    ds_read_b64_tr_b16 a[72:73], v161 offset:8192
    ds_read_b64_tr_b16 a[74:75], v161 offset:10240
    ds_read_b64_tr_b16 a[76:77], v161 offset:12288
    ds_read_b64_tr_b16 a[78:79], v161 offset:14336
    ds_read_b64_tr_b16 a[80:81], v161 offset:16384
    ds_read_b64_tr_b16 a[82:83], v161 offset:18432
    ds_read_b64_tr_b16 a[84:85], v161 offset:20480
    ds_read_b64_tr_b16 a[86:87], v161 offset:22528
    ds_read_b64_tr_b16 a[88:89], v161 offset:24576
    ds_read_b64_tr_b16 a[90:91], v161 offset:26624
    ds_read_b64_tr_b16 a[92:93], v161 offset:28672
    ds_read_b64_tr_b16 a[94:95], v161 offset:30720
    s_waitcnt vmcnt(9)
    s_barrier
    global_load_dwordx4 v[200:203], v[234:235], off offset:0 nt
    ds_read_b64_tr_b16 a[0:1], v160 offset:0
    ds_read_b64_tr_b16 a[2:3], v160 offset:2048
    global_load_dwordx4 v[204:207], v[234:235], off offset:3584 nt
    v_lshl_add_u64 v[234:235], v[234:235], 0, s[26:27]
    ds_read_b64_tr_b16 a[4:5], v160 offset:4096
    ds_read_b64_tr_b16 a[6:7], v160 offset:6144
    global_load_dwordx4 v[208:211], v[234:235], off offset:0 nt
    ds_read_b64_tr_b16 a[8:9], v160 offset:8192
    ds_read_b64_tr_b16 a[10:11], v160 offset:10240
    global_load_dwordx4 v[212:215], v[234:235], off offset:3584 nt
    v_lshl_add_u64 v[234:235], v[234:235], 0, s[26:27]
    ds_read_b64_tr_b16 a[12:13], v160 offset:12288
    ds_read_b64_tr_b16 a[14:15], v160 offset:14336
    global_load_dwordx4 v[216:219], v[234:235], off offset:0 nt
    ds_read_b64_tr_b16 a[16:17], v160 offset:16384
    ds_read_b64_tr_b16 a[18:19], v160 offset:18432
    global_load_dwordx4 v[220:223], v[234:235], off offset:3584 nt
    v_lshl_add_u64 v[234:235], v[234:235], 0, s[26:27]
    ds_read_b64_tr_b16 a[20:21], v160 offset:20480
    ds_read_b64_tr_b16 a[22:23], v160 offset:22528
    global_load_dwordx4 v[224:227], v[234:235], off offset:0 nt
    ds_read_b64_tr_b16 a[24:25], v160 offset:24576
    ds_read_b64_tr_b16 a[26:27], v160 offset:26624
    global_load_dwordx4 v[228:231], v[234:235], off offset:3584 nt
    ds_read_b64_tr_b16 a[28:29], v160 offset:28672
    ds_read_b64_tr_b16 a[30:31], v160 offset:30720
    s_waitcnt lgkmcnt(15)
    s_waitcnt vmcnt(9)
    s_barrier
    ds_read_b64_tr_b16 a[32:33], v160 offset:32768
    ds_read_b64_tr_b16 a[34:35], v160 offset:34816
    ds_read_b64_tr_b16 a[36:37], v160 offset:36864
    ds_read_b64_tr_b16 a[38:39], v160 offset:38912
    ds_read_b64_tr_b16 a[40:41], v160 offset:40960
    ds_read_b64_tr_b16 a[42:43], v160 offset:43008
    ds_read_b64_tr_b16 a[44:45], v160 offset:45056
    ds_read_b64_tr_b16 a[46:47], v160 offset:47104
    ds_read_b64_tr_b16 a[48:49], v160 offset:49152
    ds_read_b64_tr_b16 a[50:51], v160 offset:51200
    ds_read_b64_tr_b16 a[52:53], v160 offset:53248
    ds_read_b64_tr_b16 a[54:55], v160 offset:55296
    ds_read_b64_tr_b16 a[56:57], v160 offset:57344
    ds_read_b64_tr_b16 a[58:59], v160 offset:59392
    ds_read_b64_tr_b16 a[60:61], v160 offset:61440
    ds_read_b64_tr_b16 a[62:63], v160 offset:63488
    s_waitcnt vmcnt(8)
L_votes:
    v_mov_b32 v31, 0
    v_xor_b32 v22, s100, v22
    v_xor_b32 v23, s100, v23
    v_cmp_eq_u32 s[64:65], 1, v22
    v_cmp_eq_u32 s[66:67], 1, v23
    v_or_b32 v22, v22, v23
    v_and_or_b32 v31, v22, -2, v31
    v_cmp_ne_u32 vcc, 0, v31
    s_nop 0
    s_cbranch_vccnz L_retryV
    s_mov_b32 s68, 0x55555555
    s_mov_b32 s69, 0x55555555
    s_and_b64 s[70:71], s[64:65], s[68:69]
    s_bcnt1_i32_b64 s8, s[70:71]
    s_and_b64 s[70:71], s[66:67], s[68:69]
    s_bcnt1_i32_b64 s9, s[70:71]
    s_andn2_b64 s[70:71], s[64:65], s[68:69]
    s_bcnt1_i32_b64 s10, s[70:71]
    s_andn2_b64 s[70:71], s[66:67], s[68:69]
    s_bcnt1_i32_b64 s11, s[70:71]
    s_bcnt1_i32_b64 s70, s[64:65]
    s_bcnt1_i32_b64 s71, s[66:67]
    s_cmp_gt_u32 s70, s71
    s_cselect_b32 s70, 12, 19
    s_cselect_b32 s71, 19, 12
    s_cmp_gt_u32 s8, s70
    s_cselect_b32 s8, 0x2000, 0
    s_cmp_gt_u32 s9, s71
    s_cselect_b32 s9, 0x2000, 0
    s_cmp_gt_u32 s10, s70
    s_cselect_b32 s10, 0x2000, 0
    s_cmp_gt_u32 s11, s71
    s_cselect_b32 s11, 0x2000, 0
    v_xor_b32 v162, s9, v162
    v_xor_b32 v170, s10, v170
    v_xor_b32 v171, s10, v171
    v_xor_b32 v172, s10, v172
    s_xor_b32 s33, s33, s8
    s_add_u32 s33, s33, 0x60000
    s_add_u32 s58, s28, s33
    s_addc_u32 s59, s29, 0
L_pollP:
    s_load_dwordx4 s[64:67], s[58:59], 0x0 glc
    s_add_u32 s60, s60, 1
    s_cmp_gt_u32 s60, 262144
    s_cbranch_scc1 L_exit
L_pollPw:
    s_waitcnt lgkmcnt(0)
    s_xor_b64 s[64:65], s[64:65], s[100:101]
    s_xor_b64 s[66:67], s[66:67], s[100:101]
    s_or_b64 s[64:65], s[64:65], s[66:67]
    s_cbranch_scc1 L_pollP
    s_add_u32 m0, s16, 65536
    s_nop 0
    buffer_load_dwordx4 v162, s[48:51], s36 offen offset:0 sc1 lds
    buffer_load_dwordx4 v162, s[48:51], s36 offen offset:1024 sc1 lds
    buffer_load_dwordx4 v162, s[48:51], s36 offen offset:2048 sc1 lds
    s_waitcnt vmcnt(3)
    s_add_u32 m0, s16, 77824
    s_nop 0
    buffer_load_dwordx4 v162, s[48:51], s37 offen offset:0 sc1 lds
    v_perm_b32 v240, v204, v200, s61
    v_perm_b32 v241, v212, v208, s61
    v_perm_b32 v242, v220, v216, s61
    v_perm_b32 v243, v228, v224, s61
    v_perm_b32 v244, v204, v200, s62
    v_perm_b32 v245, v212, v208, s62
    v_mfma_f32_16x16x32_bf16 v[32:35], v[16:19], v[240:243], 0
    v_perm_b32 v246, v220, v216, s62
    v_perm_b32 v247, v228, v224, s62
    v_perm_b32 v240, v205, v201, s61
    v_perm_b32 v241, v213, v209, s61
    v_mfma_f32_16x16x32_bf16 v[36:39], v[16:19], v[244:247], 0
    v_perm_b32 v242, v221, v217, s61
    v_perm_b32 v243, v229, v225, s61
    v_perm_b32 v244, v205, v201, s62
    v_perm_b32 v245, v213, v209, s62
    v_mfma_f32_16x16x32_bf16 v[40:43], v[16:19], v[240:243], 0
    v_perm_b32 v246, v221, v217, s62
    v_perm_b32 v247, v229, v225, s62
    v_perm_b32 v240, v206, v202, s61
    buffer_load_dwordx4 v162, s[48:51], s37 offen offset:1024 sc1 lds
    v_perm_b32 v241, v214, v210, s61
    v_mfma_f32_16x16x32_bf16 v[44:47], v[16:19], v[244:247], 0
    v_perm_b32 v242, v222, v218, s61
    v_perm_b32 v243, v230, v226, s61
    v_perm_b32 v244, v206, v202, s62
    v_perm_b32 v245, v214, v210, s62
    v_mfma_f32_16x16x32_bf16 v[48:51], v[16:19], v[240:243], 0
    v_perm_b32 v246, v222, v218, s62
    v_perm_b32 v247, v230, v226, s62
    v_perm_b32 v240, v207, v203, s61
    v_perm_b32 v241, v215, v211, s61
    v_mfma_f32_16x16x32_bf16 v[52:55], v[16:19], v[244:247], 0
    v_perm_b32 v242, v223, v219, s61
    v_perm_b32 v243, v231, v227, s61
    v_perm_b32 v244, v207, v203, s62
    v_perm_b32 v245, v215, v211, s62
    v_mfma_f32_16x16x32_bf16 v[56:59], v[16:19], v[240:243], 0
    v_perm_b32 v246, v223, v219, s62
    v_perm_b32 v247, v231, v227, s62
    s_nop 1
    v_mfma_f32_16x16x32_bf16 v[60:63], v[16:19], v[244:247], 0
    buffer_load_dwordx4 v162, s[48:51], s37 offen offset:2048 sc1 lds
    v_fma_f32 v240, v12, v33, v32
    v_fma_f32 v241, v12, v37, v36
    v_fma_f32 v242, v12, v41, v40
    v_fma_f32 v243, v12, v45, v44
    v_fma_f32 v244, v12, v49, v48
    v_fma_f32 v245, v12, v53, v52
    v_fma_f32 v246, v12, v57, v56
    v_fma_f32 v247, v12, v61, v60
    v_mul_f32 v240, v13, v240
    v_mul_f32 v241, v13, v241
    v_mul_f32 v242, v13, v242
    v_mul_f32 v243, v13, v243
    v_mul_f32 v244, v13, v244
    v_mul_f32 v245, v13, v245
    v_mul_f32 v246, v13, v246
    v_mul_f32 v247, v13, v247
    ds_write_b128 v28, v[240:243]
    ds_write_b128 v28, v[244:247] offset:1024
    s_waitcnt lgkmcnt(0)
L_PV:
    v_mov_b32 v31, 0
    s_waitcnt vmcnt(3)
    s_barrier
    ds_read_b128 v[96:99], v163 offset:0
    ds_read_b128 v[100:103], v163 offset:1024
    ds_read_b128 v[104:107], v163 offset:2048
    ds_read_b128 v[108:111], v163 offset:3072
    ds_read_b128 v[112:115], v163 offset:4096
    ds_read_b128 v[116:119], v163 offset:5120
    ds_read_b64 v[244:245], v29 offset:0
    ds_read_b64 v[246:247], v29 offset:2048
    ds_read_b64 v[248:249], v29 offset:4096
    ds_read_b64 v[250:251], v29 offset:6144
    s_waitcnt lgkmcnt(7)
    v_add3_u32 v96, v96, v101, v107
    v_mov_b32 v101, v97
    v_mov_b32 v152, v106
    ds_read_b128 v[120:123], v163 offset:6144
    v_mfma_f32_32x32x16_bf16 v[32:47], a[4:7], v[102:105], 0
    v_bitop3_b32 v31, v31, v96, s99 bitop3:0xf6
    v_mov_b32 v144, v106
    s_add_u32 m0, s16, 90112
    s_nop 0
    buffer_load_dwordx4 v162, s[48:51], s38 offen offset:0 sc1 lds
    s_waitcnt lgkmcnt(1)
    v_add_f32 v244, v244, v246
    v_add_f32 v245, v245, v247
    ds_read_b128 v[124:127], v163 offset:7168
    ds_read_b128 v[128:131], v163 offset:8192
    v_mfma_f32_32x32x16_bf16 v[32:47], a[0:3], v[98:101], v[32:47]
    s_waitcnt lgkmcnt(7)
    v_add3_u32 v108, v108, v113, v119
    v_mov_b32 v113, v109
    v_add_f32 v152, v152, v118
    ds_read_b128 v[132:135], v163 offset:9216
    v_mfma_f32_32x32x16_bf16 v[32:47], a[12:15], v[114:117], v[32:47]
    v_bitop3_b32 v31, v31, v108, s99 bitop3:0xf6
    v_permlane32_swap_b32 v144, v118
    buffer_load_dwordx4 v162, s[48:51], s38 offen offset:1024 sc1 lds
    v_add_f32 v248, v248, v250
    v_add_f32 v249, v249, v251
    ds_read_b128 v[136:139], v163 offset:10240
    ds_read_b128 v[140:143], v163 offset:11264
    v_mfma_f32_32x32x16_bf16 v[32:47], a[8:11], v[110:113], v[32:47]
    s_waitcnt lgkmcnt(3)
    v_add3_u32 v120, v120, v125, v131
    v_mov_b32 v125, v121
    v_add_f32 v152, v152, v130
    s_waitcnt vmcnt(2)
    s_barrier
    ds_read_b128 v[96:99], v163 offset:12288
    v_mfma_f32_32x32x16_bf16 v[32:47], a[20:23], v[126:129], v[32:47]
    v_bitop3_b32 v31, v31, v120, s99 bitop3:0xf6
    buffer_load_dwordx4 v162, s[48:51], s38 offen offset:2048 sc1 lds
    ds_read_b128 v[100:103], v163 offset:13312
    ds_read_b128 v[104:107], v163 offset:14336
    v_mfma_f32_32x32x16_bf16 v[32:47], a[16:19], v[122:125], v[32:47]
    s_waitcnt lgkmcnt(3)
    v_add3_u32 v132, v132, v137, v143
    v_mov_b32 v137, v133
    v_add_f32 v152, v152, v142
    ds_read_b128 v[108:111], v163 offset:15360
    v_mfma_f32_32x32x16_bf16 v[32:47], a[28:31], v[138:141], v[32:47]
    v_bitop3_b32 v31, v31, v132, s99 bitop3:0xf6
    s_add_u32 m0, s16, 102400
    s_nop 0
    buffer_load_dwordx4 v162, s[48:51], s39 offen offset:0 sc1 lds
    ds_read_b128 v[112:115], v163 offset:16384
    ds_read_b128 v[116:119], v163 offset:17408
    v_mfma_f32_32x32x16_bf16 v[32:47], a[24:27], v[134:137], v[32:47]
    s_waitcnt lgkmcnt(3)
    v_add3_u32 v96, v96, v101, v107
    v_mov_b32 v101, v97
    v_mov_b32 v153, v106
    ds_read_b128 v[120:123], v163 offset:18432
    v_mfma_f32_32x32x16_bf16 v[48:63], a[36:39], v[102:105], 0
    v_bitop3_b32 v31, v31, v96, s99 bitop3:0xf6
    v_mov_b32 v145, v106
    buffer_load_dwordx4 v162, s[48:51], s39 offen offset:1024 sc1 lds
    ds_read_b128 v[124:127], v163 offset:19456
    ds_read_b128 v[128:131], v163 offset:20480
    v_mfma_f32_32x32x16_bf16 v[48:63], a[32:35], v[98:101], v[48:63]
    s_waitcnt lgkmcnt(3)
    v_add3_u32 v108, v108, v113, v119
    v_mov_b32 v113, v109
    v_add_f32 v153, v153, v118
    ds_read_b128 v[132:135], v163 offset:21504
    v_mfma_f32_32x32x16_bf16 v[48:63], a[44:47], v[114:117], v[48:63]
    v_bitop3_b32 v31, v31, v108, s99 bitop3:0xf6
    v_permlane32_swap_b32 v145, v118
    buffer_load_dwordx4 v162, s[48:51], s39 offen offset:2048 sc1 lds
    ds_read_b128 v[136:139], v163 offset:22528
    ds_read_b128 v[140:143], v163 offset:23552
    v_mfma_f32_32x32x16_bf16 v[48:63], a[40:43], v[110:113], v[48:63]
    s_waitcnt lgkmcnt(3)
    v_add3_u32 v120, v120, v125, v131
    v_mov_b32 v125, v121
    v_add_f32 v153, v153, v130
    s_waitcnt vmcnt(3)
    s_barrier
    ds_read_b128 v[96:99], v163 offset:24576
    v_mfma_f32_32x32x16_bf16 v[48:63], a[52:55], v[126:129], v[48:63]
    v_bitop3_b32 v31, v31, v120, s99 bitop3:0xf6
    v_add_f32 v236, v244, v248
    v_add_f32 v237, v245, v249
    buffer_store_dwordx4 v[236:239], v30, s[48:51], 0 offen sc1
    ds_read_b128 v[100:103], v163 offset:25600
    ds_read_b128 v[104:107], v163 offset:26624
    v_mfma_f32_32x32x16_bf16 v[48:63], a[48:51], v[122:125], v[48:63]
    s_waitcnt lgkmcnt(3)
    v_add3_u32 v132, v132, v137, v143
    v_mov_b32 v137, v133
    v_add_f32 v153, v153, v142
    ds_read_b128 v[108:111], v163 offset:27648
    v_mfma_f32_32x32x16_bf16 v[48:63], a[60:63], v[138:141], v[48:63]
    v_bitop3_b32 v31, v31, v132, s99 bitop3:0xf6
    ds_read_b128 v[112:115], v163 offset:28672
    ds_read_b128 v[116:119], v163 offset:29696
    v_mfma_f32_32x32x16_bf16 v[48:63], a[56:59], v[134:137], v[48:63]
    s_waitcnt lgkmcnt(3)
    v_add3_u32 v96, v96, v101, v107
    v_mov_b32 v101, v97
    v_mov_b32 v154, v106
    ds_read_b128 v[120:123], v163 offset:30720
    v_mfma_f32_32x32x16_bf16 v[64:79], a[68:71], v[102:105], 0
    v_bitop3_b32 v31, v31, v96, s99 bitop3:0xf6
    v_mov_b32 v146, v106
    ds_read_b128 v[124:127], v163 offset:31744
    ds_read_b128 v[128:131], v163 offset:32768
    v_mfma_f32_32x32x16_bf16 v[64:79], a[64:67], v[98:101], v[64:79]
    s_waitcnt lgkmcnt(3)
    v_add3_u32 v108, v108, v113, v119
    v_mov_b32 v113, v109
    v_add_f32 v154, v154, v118
    ds_read_b128 v[132:135], v163 offset:33792
    v_mfma_f32_32x32x16_bf16 v[64:79], a[76:79], v[114:117], v[64:79]
    v_bitop3_b32 v31, v31, v108, s99 bitop3:0xf6
    v_permlane32_swap_b32 v146, v118
    ds_read_b128 v[136:139], v163 offset:34816
    ds_read_b128 v[140:143], v163 offset:35840
    v_mfma_f32_32x32x16_bf16 v[64:79], a[72:75], v[110:113], v[64:79]
    s_waitcnt lgkmcnt(3)
    v_add3_u32 v120, v120, v125, v131
    v_mov_b32 v125, v121
    v_add_f32 v154, v154, v130
    s_waitcnt vmcnt(1)
    s_barrier
    ds_read_b128 v[96:99], v163 offset:36864
    v_mfma_f32_32x32x16_bf16 v[64:79], a[84:87], v[126:129], v[64:79]
    v_bitop3_b32 v31, v31, v120, s99 bitop3:0xf6
    ds_read_b128 v[100:103], v163 offset:37888
    ds_read_b128 v[104:107], v163 offset:38912
    v_mfma_f32_32x32x16_bf16 v[64:79], a[80:83], v[122:125], v[64:79]
    s_waitcnt lgkmcnt(3)
    v_add3_u32 v132, v132, v137, v143
    v_mov_b32 v137, v133
    v_add_f32 v154, v154, v142
    ds_read_b128 v[108:111], v163 offset:39936
    v_mfma_f32_32x32x16_bf16 v[64:79], a[92:95], v[138:141], v[64:79]
    v_bitop3_b32 v31, v31, v132, s99 bitop3:0xf6
    v_max3_f32 v8, v144, v145, v146
    ds_read_b128 v[112:115], v163 offset:40960
    ds_read_b128 v[116:119], v163 offset:41984
    v_mfma_f32_32x32x16_bf16 v[64:79], a[88:91], v[134:137], v[64:79]
    s_waitcnt lgkmcnt(3)
    v_add3_u32 v96, v96, v101, v107
    v_mov_b32 v101, v97
    v_mov_b32 v155, v106
    ds_read_b128 v[120:123], v163 offset:43008
    v_mfma_f32_32x32x16_bf16 v[80:95], a[100:103], v[102:105], 0
    v_bitop3_b32 v31, v31, v96, s99 bitop3:0xf6
    v_mov_b32 v147, v106
    ds_read_b128 v[124:127], v163 offset:44032
    ds_read_b128 v[128:131], v163 offset:45056
    v_mfma_f32_32x32x16_bf16 v[80:95], a[96:99], v[98:101], v[80:95]
    s_waitcnt lgkmcnt(3)
    v_add3_u32 v108, v108, v113, v119
    v_mov_b32 v113, v109
    v_add_f32 v155, v155, v118
    ds_read_b128 v[132:135], v163 offset:46080
    v_mfma_f32_32x32x16_bf16 v[80:95], a[108:111], v[114:117], v[80:95]
    v_bitop3_b32 v31, v31, v108, s99 bitop3:0xf6
    v_permlane32_swap_b32 v147, v118
    v_max_f32 v8, v8, v147
    ds_read_b128 v[136:139], v163 offset:47104
    ds_read_b128 v[140:143], v163 offset:48128
    v_mfma_f32_32x32x16_bf16 v[80:95], a[104:107], v[110:113], v[80:95]
    s_waitcnt lgkmcnt(3)
    v_add3_u32 v120, v120, v125, v131
    v_mov_b32 v125, v121
    v_add_f32 v155, v155, v130
    v_sub_f32 v156, v144, v8
    v_sub_f32 v157, v145, v8
    v_mfma_f32_32x32x16_bf16 v[80:95], a[116:119], v[126:129], v[80:95]
    v_bitop3_b32 v31, v31, v120, s99 bitop3:0xf6
    v_sub_f32 v158, v146, v8
    v_sub_f32 v159, v147, v8
    v_exp_f32 v156, v156
    v_mfma_f32_32x32x16_bf16 v[80:95], a[112:115], v[122:125], v[80:95]
    s_waitcnt lgkmcnt(0)
    v_add3_u32 v132, v132, v137, v143
    v_mov_b32 v137, v133
    v_add_f32 v155, v155, v142
    v_exp_f32 v157, v157
    v_mfma_f32_32x32x16_bf16 v[80:95], a[124:127], v[138:141], v[80:95]
    v_bitop3_b32 v31, v31, v132, s99 bitop3:0xf6
    v_exp_f32 v158, v158
    v_exp_f32 v159, v159
    v_mfma_f32_32x32x16_bf16 v[80:95], a[120:123], v[134:137], v[80:95]
    v_cmp_ne_u32 vcc, 0, v31
    v_mul_f32 v9, v156, v152
    v_fmac_f32 v9, v157, v153
    v_fmac_f32 v9, v158, v154
    v_fmac_f32 v9, v159, v155
    s_cbranch_vccnz L_retryP
    v_cmp_lt_u32 vcc, 31, v1
    s_mov_b64 exec, 15
    buffer_store_dword v232, v233, s[48:51], 0 offen sc1
    s_mov_b64 exec, -1
    v_cndmask_b32 v186, v8, v9, vcc
    v_pk_mul_f32 v[32:33], v[156:157], v[32:33] op_sel_hi:[0,1]
    v_pk_mul_f32 v[34:35], v[156:157], v[34:35] op_sel_hi:[0,1]
    v_pk_mul_f32 v[38:39], v[156:157], v[38:39] op_sel_hi:[0,1]
    v_pk_fma_f32 v[32:33], v[156:157], v[48:49], v[32:33] op_sel:[1,0,0]
    v_pk_fma_f32 v[34:35], v[156:157], v[50:51], v[34:35] op_sel:[1,0,0]
    v_pk_fma_f32 v[38:39], v[156:157], v[54:55], v[38:39] op_sel:[1,0,0]
    v_pk_fma_f32 v[32:33], v[158:159], v[64:65], v[32:33] op_sel_hi:[0,1,1]
    v_pk_fma_f32 v[34:35], v[158:159], v[66:67], v[34:35] op_sel_hi:[0,1,1]
    v_pk_fma_f32 v[38:39], v[158:159], v[70:71], v[38:39] op_sel_hi:[0,1,1]
    v_pk_fma_f32 v[32:33], v[158:159], v[80:81], v[32:33] op_sel:[1,0,0]
    v_pk_fma_f32 v[34:35], v[158:159], v[82:83], v[34:35] op_sel:[1,0,0]
    v_pk_fma_f32 v[38:39], v[158:159], v[86:87], v[38:39] op_sel:[1,0,0]
    v_cvt_pk_bf16_f32 v178, v32, v33
    v_cvt_pk_bf16_f32 v179, v34, v35
    v_cvt_pk_bf16_f32 v177, v38, v39
    ds_write_b128 v164, v[176:179]
    v_pk_mul_f32 v[36:37], v[156:157], v[36:37] op_sel_hi:[0,1]
    v_pk_mul_f32 v[40:41], v[156:157], v[40:41] op_sel_hi:[0,1]
    v_pk_mul_f32 v[42:43], v[156:157], v[42:43] op_sel_hi:[0,1]
    v_pk_fma_f32 v[36:37], v[156:157], v[52:53], v[36:37] op_sel:[1,0,0]
    v_pk_fma_f32 v[40:41], v[156:157], v[56:57], v[40:41] op_sel:[1,0,0]
    v_pk_fma_f32 v[42:43], v[156:157], v[58:59], v[42:43] op_sel:[1,0,0]
    v_pk_fma_f32 v[36:37], v[158:159], v[68:69], v[36:37] op_sel_hi:[0,1,1]
    v_pk_fma_f32 v[40:41], v[158:159], v[72:73], v[40:41] op_sel_hi:[0,1,1]
    v_pk_fma_f32 v[42:43], v[158:159], v[74:75], v[42:43] op_sel_hi:[0,1,1]
    v_pk_fma_f32 v[36:37], v[158:159], v[84:85], v[36:37] op_sel:[1,0,0]
    v_pk_fma_f32 v[40:41], v[158:159], v[88:89], v[40:41] op_sel:[1,0,0]
    v_pk_fma_f32 v[42:43], v[158:159], v[90:91], v[42:43] op_sel:[1,0,0]
    v_cvt_pk_bf16_f32 v180, v36, v37
    v_cvt_pk_bf16_f32 v182, v40, v41
    v_cvt_pk_bf16_f32 v183, v42, v43
    ds_write_b128 v165, v[180:183]
    v_pk_mul_f32 v[44:45], v[156:157], v[44:45] op_sel_hi:[0,1]
    v_pk_mul_f32 v[46:47], v[156:157], v[46:47] op_sel_hi:[0,1]
    v_pk_fma_f32 v[44:45], v[156:157], v[60:61], v[44:45] op_sel:[1,0,0]
    v_pk_fma_f32 v[46:47], v[156:157], v[62:63], v[46:47] op_sel:[1,0,0]
    v_pk_fma_f32 v[44:45], v[158:159], v[76:77], v[44:45] op_sel_hi:[0,1,1]
    v_pk_fma_f32 v[46:47], v[158:159], v[78:79], v[46:47] op_sel_hi:[0,1,1]
    v_pk_fma_f32 v[44:45], v[158:159], v[92:93], v[44:45] op_sel:[1,0,0]
    v_pk_fma_f32 v[46:47], v[158:159], v[94:95], v[46:47] op_sel:[1,0,0]
    v_cvt_pk_bf16_f32 v184, v44, v45
    v_cvt_pk_bf16_f32 v185, v46, v47
    ds_write_b128 v166, v[184:187]
    s_waitcnt lgkmcnt(0)
    s_barrier
    ds_read_b128 v[188:191], v167
    ds_read_b128 v[192:195], v168
    ds_read_b128 v[196:199], v169
    s_waitcnt lgkmcnt(2)
    buffer_store_dwordx4 v[188:191], v170, s[48:51], 0 offen sc1
    s_waitcnt lgkmcnt(1)
    buffer_store_dwordx4 v[192:195], v171, s[48:51], 0 offen sc1
    s_waitcnt lgkmcnt(0)
    buffer_store_dwordx4 v[196:199], v172, s[48:51], 0 offen sc1
    s_cmp_ge_u32 s32, 12
    s_cbranch_scc1 L_exit
    s_mul_i32 s3, s31, 12
    s_add_u32 s3, s3, s32
    s_lshr_b32 s34, s31, 1
    s_mul_i32 s35, s34, 24
    s_sub_u32 s35, s3, s35
    s_lshr_b32 s33, s35, 3
    s_lshl_b32 s34, s34, 8
    s_mul_i32 s57, s33, 6
    s_add_u32 s34, s34, s57
    s_bfe_u32 s57, s35, 0x20001
    s_lshl_b32 s57, s57, 10
    s_add_u32 s34, s34, s57
    s_and_b32 s57, s35, 1
    s_lshl_b32 s57, s57, 7
    s_add_u32 s34, s34, s57
    v_and_b32 v3, 7, v1
    v_lshl_add_u32 v5, v3, 4, s34
    v_lshl_add_u32 v5, v4, 1, v5
    s_mov_b32 s52, s4
    s_and_b32 s53, s5, 0xffff
    s_mov_b32 s54, 0x1000
    s_mov_b32 s55, 0x20000
    buffer_load_ushort v7, v5, s[52:55], 0 offen
    v_lshlrev_b32 v12, 2, v1
    v_add_u32 v12, 147456, v12
    s_lshl_b32 s35, s30, 8
    v_add_u32 v13, s35, v12
    s_lshr_b32 s35, s31, 2
    s_lshl_b32 s34, s35, 4
    s_add_u32 s34, s34, s3
    s_lshl_b32 s34, s34, 7
    s_lshl_b32 s35, s30, 19
    s_add_u32 s34, s34, s35
    s_xor_b32 s34, s34, s11
    s_add_u32 s34, s34, 6291456
    v_lshrrev_b32 v6, 3, v1
    v_lshl_add_u32 v8, v6, 14, s34
    v_lshl_add_u32 v8, v3, 4, v8
    s_mov_b32 s36, 131072
    s_mov_b32 s37, 262144
    s_mov_b32 s38, 393216
    s_cmp_eq_u32 s33, 2
    s_cselect_b32 s33, 0, 0xff
    s_and_b32 s57, s3, 15
    s_and_b32 s35, s3, 8
    s_add_u32 s57, s57, s35
    s_and_b32 s35, s31, 4
    s_lshl_b32 s35, s35, 1
    s_add_u32 s57, s57, s35
    s_lshl_b32 s57, s57, 2
    s_add_u32 s57, s57, s30
    s_lshl_b32 s57, s57, 8
    s_xor_b32 s57, s57, s8
    s_add_u32 s57, s57, 0x90000
    s_add_u32 s58, s28, s57
    s_addc_u32 s59, s29, 0
    s_mov_b32 s44, s24
    s_and_b32 s45, s25, 0xffff
    s_mov_b32 s46, 0x1000
    s_mov_b32 s47, 0x20000
    buffer_load_dwordx4 v[32:35], v8, s[48:51], 0 offen sc1
    buffer_load_dwordx4 v[36:39], v8, s[48:51], s36 offen sc1
    buffer_load_dwordx4 v[40:43], v8, s[48:51], s37 offen sc1
    buffer_load_dwordx4 v[44:47], v8, s[48:51], s38 offen sc1
    v_readfirstlane_b32 s34, v5
    s_nop 0
    s_and_b32 s34, s34, 0xf80
    s_load_dword s80, s[24:25], s34 glc
    s_load_dword s81, s[24:25], s34 offset:64 glc
    s_waitcnt lgkmcnt(0)
    s_waitcnt vmcnt(0)
    v_lshlrev_b32 v14, 16, v7
L_pollO0:
    s_load_dwordx8 s[64:71], s[58:59], 0x0 glc
    s_load_dwordx8 s[72:79], s[58:59], 0x40 glc
    s_load_dwordx8 s[80:87], s[58:59], 0x80 glc
    s_load_dwordx8 s[88:95], s[58:59], 0xc0 glc
    s_add_u32 s60, s60, 1
    s_cmp_gt_u32 s60, 262144
    s_cbranch_scc1 L_exit
    s_waitcnt lgkmcnt(0)
L_pollOt0:
    s_xor_b64 s[64:65], s[64:65], s[100:101]
    s_xor_b64 s[66:67], s[66:67], s[100:101]
    s_xor_b64 s[68:69], s[68:69], s[100:101]
    s_xor_b64 s[70:71], s[70:71], s[100:101]
    s_or_b64 s[64:65], s[64:65], s[68:69]
    s_or_b64 s[66:67], s[66:67], s[70:71]
    s_or_b64 s[64:65], s[64:65], s[66:67]
    s_cbranch_scc1 L_pollO0
L_pollOt1:
    s_xor_b64 s[72:73], s[72:73], s[100:101]
    s_xor_b64 s[74:75], s[74:75], s[100:101]
    s_xor_b64 s[76:77], s[76:77], s[100:101]
    s_xor_b64 s[78:79], s[78:79], s[100:101]
    s_or_b64 s[72:73], s[72:73], s[76:77]
    s_or_b64 s[74:75], s[74:75], s[78:79]
    s_or_b64 s[72:73], s[72:73], s[74:75]
    s_cbranch_scc1 L_pollO1
L_pollOt2:
    s_xor_b64 s[80:81], s[80:81], s[100:101]
    s_xor_b64 s[82:83], s[82:83], s[100:101]
    s_xor_b64 s[84:85], s[84:85], s[100:101]
    s_xor_b64 s[86:87], s[86:87], s[100:101]
    s_or_b64 s[80:81], s[80:81], s[84:85]
    s_or_b64 s[82:83], s[82:83], s[86:87]
    s_or_b64 s[80:81], s[80:81], s[82:83]
    s_cbranch_scc1 L_pollO2
L_pollOt3:
    s_xor_b64 s[88:89], s[88:89], s[100:101]
    s_xor_b64 s[90:91], s[90:91], s[100:101]
    s_xor_b64 s[92:93], s[92:93], s[100:101]
    s_xor_b64 s[94:95], s[94:95], s[100:101]
    s_or_b64 s[88:89], s[88:89], s[92:93]
    s_or_b64 s[90:91], s[90:91], s[94:95]
    s_or_b64 s[88:89], s[88:89], s[90:91]
    s_cbranch_scc1 L_pollO3
L_loadO:
    buffer_load_dwordx4 v[32:35], v8, s[48:51], 0 offen sc1
    buffer_load_dwordx4 v[36:39], v8, s[48:51], s36 offen sc1
    buffer_load_dwordx4 v[40:43], v8, s[48:51], s37 offen sc1
    buffer_load_dwordx4 v[44:47], v8, s[48:51], s38 offen sc1
    v_mov_b32 v31, 0
    s_add_u32 s60, s60, 1
    s_cmp_gt_u32 s60, 262144
    s_cbranch_scc1 L_exit
    s_waitcnt vmcnt(2)
    v_bitop3_b32 v31, v31, v35, s100 bitop3:0xf6
    v_bitop3_b32 v31, v31, v39, s100 bitop3:0xf6
    v_pk_add_f32 v[32:33], v[32:33], v[36:37]
    v_add_f32 v34, v34, v38
    s_waitcnt vmcnt(1)
    v_bitop3_b32 v31, v31, v43, s100 bitop3:0xf6
    v_pk_add_f32 v[32:33], v[32:33], v[40:41]
    v_add_f32 v34, v34, v42
    s_waitcnt vmcnt(0)
    v_pk_add_f32 v[32:33], v[32:33], v[44:45]
    v_add_f32 v34, v34, v46
    v_bitop3_b32 v31, v31, v47, s100 bitop3:0xf6
    v_cmp_ne_u32 vcc, 0, v31
    v_permlane32_swap_b32 v32, v34
    v_permlane32_swap_b32 v33, v35
    s_cbranch_vccnz L_loadO
    v_pk_add_f32 v[32:33], v[32:33], v[34:35]
    s_cmp_lg_u32 s30, 0
    s_nop 0
    v_permlane16_swap_b32 v32, v33
    v_add_f32 v32, v32, v33
    s_nop 1
    v_add_f32_dpp v32, v32, v32 row_ror:8 row_mask:0xf bank_mask:0xf
    ds_write_b32 v13, v32
    v_add_f32 v14, v14, v32
    s_waitcnt lgkmcnt(0)
    s_barrier
    s_cbranch_scc1 L_exit
    ds_read2st64_b32 v[34:35], v12 offset0:1 offset1:2
    ds_read_b32 v36, v12 offset:768
    s_mov_b32 exec_lo, 0x00ff00ff
    s_mov_b32 exec_hi, s33
    s_waitcnt lgkmcnt(1)
    v_add_f32 v14, v14, v34
    v_add_f32 v14, v14, v35
    s_waitcnt lgkmcnt(0)
    v_add_f32 v14, v14, v36
    v_cvt_pk_bf16_f32 v7, v14, v14
    buffer_store_short v7, v5, s[44:47], 0 offen
    s_branch L_exit
L_pollO1:
    s_load_dwordx8 s[72:79], s[58:59], 0x40 glc
    s_load_dwordx8 s[80:87], s[58:59], 0x80 glc
    s_load_dwordx8 s[88:95], s[58:59], 0xc0 glc
    s_add_u32 s60, s60, 1
    s_cmp_gt_u32 s60, 262144
    s_cbranch_scc1 L_exit
    s_waitcnt lgkmcnt(0)
    s_branch L_pollOt1
L_pollO2:
    s_load_dwordx8 s[80:87], s[58:59], 0x80 glc
    s_load_dwordx8 s[88:95], s[58:59], 0xc0 glc
    s_add_u32 s60, s60, 1
    s_cmp_gt_u32 s60, 262144
    s_cbranch_scc1 L_exit
    s_waitcnt lgkmcnt(0)
    s_branch L_pollOt2
L_pollO3:
    s_load_dwordx8 s[88:95], s[58:59], 0xc0 glc
    s_add_u32 s60, s60, 1
    s_cmp_gt_u32 s60, 262144
    s_cbranch_scc1 L_exit
    s_waitcnt lgkmcnt(0)
    s_branch L_pollOt3
L_retryV:
    s_add_u32 s60, s60, 1
    s_cmp_gt_u32 s60, 262144
    s_cbranch_scc1 L_exit
    buffer_load_dwordx2 v[22:23], v20, s[48:51], 0 offen sc1
    s_waitcnt vmcnt(0)
    s_branch L_votes
L_retryP:
    s_add_u32 s60, s60, 1
    s_cmp_gt_u32 s60, 262144
    s_cbranch_scc1 L_exit
    s_waitcnt vmcnt(0) lgkmcnt(0)
    s_barrier
    s_add_u32 m0, s16, 65536
    s_nop 0
    buffer_load_dwordx4 v162, s[48:51], s36 offen offset:0 sc1 lds
    buffer_load_dwordx4 v162, s[48:51], s36 offen offset:1024 sc1 lds
    buffer_load_dwordx4 v162, s[48:51], s36 offen offset:2048 sc1 lds
    s_add_u32 m0, s16, 77824
    s_nop 0
    buffer_load_dwordx4 v162, s[48:51], s37 offen offset:0 sc1 lds
    buffer_load_dwordx4 v162, s[48:51], s37 offen offset:1024 sc1 lds
    buffer_load_dwordx4 v162, s[48:51], s37 offen offset:2048 sc1 lds
    s_add_u32 m0, s16, 90112
    s_nop 0
    buffer_load_dwordx4 v162, s[48:51], s38 offen offset:0 sc1 lds
    buffer_load_dwordx4 v162, s[48:51], s38 offen offset:1024 sc1 lds
    buffer_load_dwordx4 v162, s[48:51], s38 offen offset:2048 sc1 lds
    s_add_u32 m0, s16, 102400
    s_nop 0
    buffer_load_dwordx4 v162, s[48:51], s39 offen offset:0 sc1 lds
    buffer_load_dwordx4 v162, s[48:51], s39 offen offset:1024 sc1 lds
    buffer_load_dwordx4 v162, s[48:51], s39 offen offset:2048 sc1 lds
    s_waitcnt vmcnt(0)
    s_branch L_PV
L_exit:
L_end:
    s_endpgm
.section .rodata,"a"
.p2align 6
.amdhsa_kernel parallel_sum__compressed_kv_cla__glu_gated_geglu__decode_kernel
  .amdhsa_next_free_vgpr 384
  .amdhsa_next_free_sgpr 102
  .amdhsa_accum_offset 256
  .amdhsa_group_segment_fixed_size 0
  .amdhsa_kernarg_size 104
  .amdhsa_user_sgpr_count 2
  .amdhsa_user_sgpr_kernarg_segment_ptr 1
  .amdhsa_system_sgpr_workgroup_id_x 1
.end_amdhsa_kernel
```
